```python
import torch

def _softmax(x, axis=-1):
    return torch.softmax(x, dim=axis)

def _gelu(x):
    return torch.nn.functional.gelu(x, approximate='tanh')

def _silu(x):
    return torch.nn.functional.silu(x)

def _sigmoid(x):
    return torch.sigmoid(x)

def _layernorm(x, axis=-1, eps=1e-05):
    m = x.mean(dim=axis, keepdim=True)
    v = x.var(dim=axis, keepdim=True, unbiased=False)
    return (x - m) / torch.sqrt(v + eps)

def _scatter_add(tgt, idx, src, axis=0):
    return tgt.clone().index_add_(axis, idx, src)

def _segment_sum(src, seg, n):
    out = torch.zeros((n,) + src.shape[1:], dtype=src.dtype)
    return out.index_add_(0, seg, src)

def _pad(x, pw):
    flat = tuple((v for pair in reversed(pw) for v in pair))
    return torch.nn.functional.pad(x, flat)
kernel_name = 'standalone__tensor_product_equiv_mace__graph'

def setup_inputs():

    _w = lambda a: (lambda t: t.to(torch.bfloat16) if t.is_floating_point() else t)(torch.as_tensor(a))
    N, deg = (25000, 32)
    Lmax, C, De = (1, 64, 16)
    M = (Lmax + 1) ** 2
    E = N * deg
    src = (lambda lo, hi, *s: torch.randint(lo, hi, s))(0, N, E).to(torch.int64)
    dst = (lambda lo, hi, *s: torch.randint(lo, hi, s))(0, N, E).to(torch.int64)
    r = (lambda *s: torch.randn(*s, dtype=torch.bfloat16) * 0.05)(E, 3).to(float)
    r = r / (torch.linalg.norm(r, dim=-1, keepdim=True).to(float) + 1e-06)
    rx, ry, rz = (r[:, 0].clone(), r[:, 1].clone(), r[:, 2].clone())
    x2, y2, z2 = (rx * rx, ry * ry, rz * rz)
    sh_list = [torch.ones_like(rx), rx, ry, rz, rx * ry, ry * rz, 2.0 * z2 - x2 - y2, rx * rz, x2 - y2, ry * (3.0 * x2 - y2), rx * ry * rz, ry * (4.0 * z2 - x2 - y2), rz * (2.0 * z2 - 3.0 * x2 - 3.0 * y2), rx * (4.0 * z2 - x2 - y2), rz * (x2 - y2), rx * (x2 - 3.0 * y2)]
    sh16 = torch.stack(sh_list, dim=-1).to(float)
    pad = max(0, M - 16)
    sh_full = torch.cat([sh16, torch.zeros((E, pad), dtype=float)], dim=-1)[:, :M]
    cg = ((lambda *s: torch.randn(*s, dtype=torch.bfloat16) * 0.05)(M, M, M) * (1.0 / float(M))).to(float)
    return {'x': _w(((lambda *s: torch.randn(*s, dtype=torch.bfloat16) * 0.05)(N, M, C) * 0.3).to(float)), 'src': _w(src), 'dst': _w(dst), 'sh': _w(sh_full.to(float)), 'edge_attr': _w(((lambda *s: torch.randn(*s, dtype=torch.bfloat16) * 0.05)(E, De) * 0.3).to(float)), 'cg': _w(cg), 'w_r': _w(((lambda *s: torch.randn(*s, dtype=torch.bfloat16) * 0.05)(De, C) * (1.0 / float(De) ** 0.5)).to(float)), 'w_out': _w(((lambda *s: torch.randn(*s, dtype=torch.bfloat16) * 0.05)(C, C) * (1.0 / float(C) ** 0.5)).to(float))}

def reference(x, src, dst, sh, edge_attr, cg, w_r, w_out):
    N = x.shape[0]
    M = x.shape[1]
    C = x.shape[2]
    h = x[src]
    tp = torch.einsum('uvw,euc,ev->ewc', cg, h, sh)
    rw = edge_attr @ w_r
    msg = tp * rw[:, None, :]
    msg2 = msg.reshape(-1, M * C)
    agg = _segment_sum(msg2, dst, N).reshape(N, M, C)
    out = torch.einsum('nmc,cd->nmd', agg, w_out)
    return out
```

```asm
; @launch grid=(256,1,1) block=(1024,1,1) lds=163840
.amdgcn_target "amdgcn-amd-amdhsa--gfx950"
.text
.globl standalone__tensor_product_equiv_mace__graph_kernel
.p2align 8
.type standalone__tensor_product_equiv_mace__graph_kernel,@function
standalone__tensor_product_equiv_mace__graph_kernel:
    s_cmp_ge_u32 s2, 256
    s_cbranch_scc1 Lend
    v_readfirstlane_b32 s14, v0
    s_cmp_ge_u32 s14, 640
    s_cbranch_scc1 Lspare
    s_cmp_eq_u32 s14, 0
    s_cbranch_scc1 Lsort5
    s_cmp_eq_u32 s2, 255
    s_cbranch_scc1 Lprep
    s_cmp_eq_u32 s14, 576
    s_cbranch_scc1 Lsort4
Lsort5:
    s_load_dwordx4 s[4:7], s[0:1], 8
    s_load_dwordx4 s[8:11], s[0:1], 24
    s_load_dwordx2 s[12:13], s[0:1], 80
    s_lshr_b32 s14, s14, 6
    v_and_b32 v2, 63, v0
    v_lshlrev_b32 v3, 2, v2
    v_lshlrev_b32 v4, 3, v2
    v_lshlrev_b32 v5, 4, v2
    s_mul_i32 s15, s2, 3136
    s_mul_i32 s16, s14, 320
    s_add_u32 s15, s15, s16
    s_lshl_b32 s17, s15, 2
    s_lshl_b32 s18, s15, 3
    s_lshl_b32 s19, s15, 5
    s_waitcnt lgkmcnt(0)
    s_add_u32 s6, s6, s17
    s_addc_u32 s7, s7, 0
    global_load_dword v10, v3, s[6:7] offset:0 nt
    global_load_dword v11, v3, s[6:7] offset:256 nt
    global_load_dword v12, v3, s[6:7] offset:512 nt
    global_load_dword v13, v3, s[6:7] offset:768 nt
    global_load_dword v14, v3, s[6:7] offset:1024 nt
    s_add_u32 s4, s4, s17
    s_addc_u32 s5, s5, 0
    global_load_dword v15, v3, s[4:5] offset:0 nt
    global_load_dword v16, v3, s[4:5] offset:256 nt
    global_load_dword v17, v3, s[4:5] offset:512 nt
    global_load_dword v18, v3, s[4:5] offset:768 nt
    global_load_dword v19, v3, s[4:5] offset:1024 nt
    s_add_u32 s8, s8, s18
    s_addc_u32 s9, s9, 0
    global_load_dwordx2 v[20:21], v4, s[8:9] offset:0 nt
    global_load_dwordx2 v[22:23], v4, s[8:9] offset:512 nt
    global_load_dwordx2 v[24:25], v4, s[8:9] offset:1024 nt
    global_load_dwordx2 v[26:27], v4, s[8:9] offset:1536 nt
    global_load_dwordx2 v[28:29], v4, s[8:9] offset:2048 nt
    s_barrier
    s_add_u32 s10, s10, s19
    s_addc_u32 s11, s11, 0
    s_lshl_b32 s20, s16, 5
    s_add_u32 s20, s20, 53248
    s_add_u32 m0, s20, 0
    v_add_u32 v6, 0, v5
    global_load_lds_dwordx4 v6, s[10:11] offset:0 nt
    global_load_lds_dwordx4 v6, s[10:11] offset:1024 nt
    global_load_lds_dwordx4 v6, s[10:11] offset:2048 nt
    global_load_lds_dwordx4 v6, s[10:11] offset:3072 nt
    s_add_u32 m0, s20, 4096
    v_add_u32 v6, 4096, v5
    global_load_lds_dwordx4 v6, s[10:11] offset:0 nt
    global_load_lds_dwordx4 v6, s[10:11] offset:1024 nt
    global_load_lds_dwordx4 v6, s[10:11] offset:2048 nt
    global_load_lds_dwordx4 v6, s[10:11] offset:3072 nt
    s_add_u32 m0, s20, 8192
    v_add_u32 v6, 8192, v5
    global_load_lds_dwordx4 v6, s[10:11] offset:0 nt
    global_load_lds_dwordx4 v6, s[10:11] offset:1024 nt
    s_mov_b32 s21, 42800
    s_mov_b32 s22, -98
    v_mov_b32 v7, 1
    s_waitcnt vmcnt(20)
    v_mul_u32_u24 v30, s21, v10
    v_lshrrev_b32 v30, 22, v30
    v_mad_i32_i24 v10, v30, s22, v10
    v_lshlrev_b32 v30, 2, v30
    ds_add_rtn_u32 v35, v30, v7 offset:0
    v_mul_u32_u24 v31, s21, v11
    v_lshrrev_b32 v31, 22, v31
    v_mad_i32_i24 v11, v31, s22, v11
    v_lshlrev_b32 v31, 2, v31
    ds_add_rtn_u32 v36, v31, v7 offset:0
    v_mul_u32_u24 v32, s21, v12
    v_lshrrev_b32 v32, 22, v32
    v_mad_i32_i24 v12, v32, s22, v12
    v_lshlrev_b32 v32, 2, v32
    ds_add_rtn_u32 v37, v32, v7 offset:0
    v_mul_u32_u24 v33, s21, v13
    v_lshrrev_b32 v33, 22, v33
    v_mad_i32_i24 v13, v33, s22, v13
    v_lshlrev_b32 v33, 2, v33
    ds_add_rtn_u32 v38, v33, v7 offset:0
    v_mul_u32_u24 v34, s21, v14
    v_lshrrev_b32 v34, 22, v34
    v_mad_i32_i24 v14, v34, s22, v14
    v_lshlrev_b32 v34, 2, v34
    ds_add_rtn_u32 v39, v34, v7 offset:0
    s_waitcnt lgkmcnt(0)
    s_barrier
    ds_read_b128 v[40:43], v5 offset:0
    s_waitcnt vmcnt(10)
    v_lshlrev_b32 v10, 2, v10
    v_lshl_or_b32 v15, v15, 17, v10
    v_lshlrev_b32 v11, 2, v11
    v_lshl_or_b32 v16, v16, 17, v11
    v_lshlrev_b32 v12, 2, v12
    v_lshl_or_b32 v17, v17, 17, v12
    v_lshlrev_b32 v13, 2, v13
    v_lshl_or_b32 v18, v18, 17, v13
    v_lshlrev_b32 v14, 2, v14
    v_lshl_or_b32 v19, v19, 17, v14
    v_lshl_add_u32 v53, v2, 5, s20
    s_waitcnt lgkmcnt(0)
    v_add_u32 v44, v40, v41
    v_add_u32 v45, v44, v42
    v_add_u32 v47, v45, v43
    v_mov_b32 v46, v47
    v_add_u32 v54, 2048, v53
    s_nop 0
    v_add_u32_dpp v46, v46, v46 row_shr:1 row_mask:0xf bank_mask:0xf
    v_add_u32 v55, 4096, v53
    s_nop 0
    v_add_u32_dpp v46, v46, v46 row_shr:2 row_mask:0xf bank_mask:0xf
    v_add_u32 v56, 6144, v53
    s_nop 0
    v_add_u32_dpp v46, v46, v46 row_shr:4 row_mask:0xf bank_mask:0xf
    v_add_u32 v57, 8192, v53
    s_nop 0
    v_add_u32_dpp v46, v46, v46 row_shr:8 row_mask:0xf bank_mask:0xf
    s_nop 1
    v_add_u32_dpp v46, v46, v46 row_bcast:15 row_mask:0xa bank_mask:0xf
    s_nop 1
    v_add_u32_dpp v46, v46, v46 row_bcast:31 row_mask:0xc bank_mask:0xf
    v_sub_u32 v46, v46, v47
    v_add_u32 v41, v46, v40
    v_add_u32 v42, v46, v44
    v_add_u32 v43, v46, v45
    v_mov_b32 v40, v46
    ds_write_b128 v5, v[40:43] offset:1024
    ds_read_b32 v30, v30 offset:1024
    ds_read_b32 v31, v31 offset:1024
    ds_read_b32 v32, v32 offset:1024
    ds_read_b32 v33, v33 offset:1024
    ds_read_b32 v34, v34 offset:1024
    s_mov_b32 s23, 14848
    s_waitcnt lgkmcnt(4)
    v_add_u32 v30, v30, v35
    v_lshlrev_b32 v35, 2, v30
    v_mad_u32_u24 v30, v30, 12, s23
    ds_write_b32 v35, v53 offset:2048
    ds_write_b32 v30, v15
    ds_write2_b32 v30, v20, v21 offset0:1 offset1:2
    s_waitcnt lgkmcnt(6)
    v_add_u32 v31, v31, v36
    v_lshlrev_b32 v36, 2, v31
    v_mad_u32_u24 v31, v31, 12, s23
    ds_write_b32 v36, v54 offset:2048
    ds_write_b32 v31, v16
    ds_write2_b32 v31, v22, v23 offset0:1 offset1:2
    s_waitcnt lgkmcnt(8)
    v_add_u32 v32, v32, v37
    v_lshlrev_b32 v37, 2, v32
    v_mad_u32_u24 v32, v32, 12, s23
    ds_write_b32 v37, v55 offset:2048
    ds_write_b32 v32, v17
    ds_write2_b32 v32, v24, v25 offset0:1 offset1:2
    s_waitcnt lgkmcnt(10)
    v_add_u32 v33, v33, v38
    v_lshlrev_b32 v38, 2, v33
    v_mad_u32_u24 v33, v33, 12, s23
    ds_write_b32 v38, v56 offset:2048
    ds_write_b32 v33, v18
    ds_write2_b32 v33, v26, v27 offset0:1 offset1:2
    s_waitcnt lgkmcnt(12)
    v_add_u32 v34, v34, v39
    v_lshlrev_b32 v39, 2, v34
    v_mad_u32_u24 v34, v34, 12, s23
    ds_write_b32 v39, v57 offset:2048
    ds_write_b32 v34, v19
    ds_write2_b32 v34, v28, v29 offset0:1 offset1:2
    s_mul_i32 s23, s14, 3840
    v_add_u32 v8, s23, v5
    v_lshrrev_b32 v9, 1, v2
    v_add_lshl_u32 v9, v9, s16, 2
    s_mul_i32 s23, s2, 37632
    s_add_u32 s23, s23, 1048576
    s_add_u32 s26, s12, s23
    s_addc_u32 s27, s13, 0
    s_add_u32 s19, s19, 11534336
    s_add_u32 s28, s12, s19
    s_addc_u32 s29, s13, 0
    v_and_b32 v10, 1, v2
    v_lshlrev_b32 v10, 4, v10
    v_add_u32 v6, 4096, v5
    v_add_u32 v7, 8192, v5
    s_waitcnt lgkmcnt(0)
    s_barrier
    ds_read_b128 v[12:15], v8 offset:14848
    ds_read_b128 v[16:19], v8 offset:15872
    ds_read_b128 v[20:23], v8 offset:16896
    ds_read_b128 v[24:27], v8 offset:17920
    ds_read_b32 v30, v9 offset:2048
    ds_read_b32 v31, v9 offset:2176
    ds_read_b32 v32, v9 offset:2304
    ds_read_b32 v33, v9 offset:2432
    ds_read_b32 v34, v9 offset:2560
    ds_read_b32 v35, v9 offset:2688
    ds_read_b32 v36, v9 offset:2816
    ds_read_b32 v37, v9 offset:2944
    ds_read_b32 v38, v9 offset:3072
    ds_read_b32 v39, v9 offset:3200
    s_waitcnt lgkmcnt(13)
    global_store_dwordx4 v8, v[12:15], s[26:27] offset:0 sc1
    s_waitcnt lgkmcnt(12)
    global_store_dwordx4 v8, v[16:19], s[26:27] offset:1024 sc1
    s_waitcnt lgkmcnt(11)
    global_store_dwordx4 v8, v[20:23], s[26:27] offset:2048 sc1
    s_waitcnt lgkmcnt(10)
    s_mov_b32 exec_hi, 0xffff
    global_store_dwordx4 v8, v[24:27], s[26:27] offset:3072 sc1
    s_mov_b64 exec, -1
    s_waitcnt lgkmcnt(0)
    v_add_u32 v30, v30, v10
    v_add_u32 v31, v31, v10
    v_add_u32 v32, v32, v10
    v_add_u32 v33, v33, v10
    v_add_u32 v34, v34, v10
    v_add_u32 v35, v35, v10
    v_add_u32 v36, v36, v10
    v_add_u32 v37, v37, v10
    v_add_u32 v38, v38, v10
    v_add_u32 v39, v39, v10
    s_waitcnt vmcnt(0)
    s_barrier
    ds_read_b128 v[40:43], v30
    ds_read_b128 v[44:47], v31
    ds_read_b128 v[48:51], v32
    ds_read_b128 v[52:55], v33
    ds_read_b128 v[56:59], v34
    ds_read_b128 v[60:63], v35
    ds_read_b128 v[64:67], v36
    ds_read_b128 v[68:71], v37
    ds_read_b128 v[72:75], v38
    ds_read_b128 v[76:79], v39
    s_waitcnt lgkmcnt(9)
    global_store_dwordx4 v5, v[40:43], s[28:29] offset:0 sc1
    s_waitcnt lgkmcnt(8)
    global_store_dwordx4 v5, v[44:47], s[28:29] offset:1024 sc1
    s_waitcnt lgkmcnt(7)
    global_store_dwordx4 v5, v[48:51], s[28:29] offset:2048 sc1
    s_waitcnt vmcnt(2) lgkmcnt(6)
    global_store_dwordx4 v5, v[52:55], s[28:29] offset:3072 sc1
    s_waitcnt vmcnt(2) lgkmcnt(5)
    global_store_dwordx4 v6, v[56:59], s[28:29] offset:0 sc1
    s_waitcnt vmcnt(2) lgkmcnt(4)
    global_store_dwordx4 v6, v[60:63], s[28:29] offset:1024 sc1
    s_waitcnt vmcnt(2) lgkmcnt(3)
    global_store_dwordx4 v6, v[64:67], s[28:29] offset:2048 sc1
    s_waitcnt vmcnt(2) lgkmcnt(2)
    global_store_dwordx4 v6, v[68:71], s[28:29] offset:3072 sc1
    s_waitcnt vmcnt(2) lgkmcnt(1)
    global_store_dwordx4 v7, v[72:75], s[28:29] offset:0 sc1
    s_waitcnt vmcnt(2) lgkmcnt(0)
    global_store_dwordx4 v7, v[76:79], s[28:29] offset:1024 sc1
    s_waitcnt lgkmcnt(0)
    v_mov_b32 v9, 156680
    v_mov_b32 v11, 1
    s_mov_b64 exec, 1
    ds_add_u32 v9, v11
    s_mov_b64 exec, -1
    s_branch Ljoin
Lsort4:
    s_load_dwordx4 s[4:7], s[0:1], 8
    s_load_dwordx4 s[8:11], s[0:1], 24
    s_load_dwordx2 s[12:13], s[0:1], 80
    s_lshr_b32 s14, s14, 6
    v_and_b32 v2, 63, v0
    v_lshlrev_b32 v3, 2, v2
    v_lshlrev_b32 v4, 3, v2
    v_lshlrev_b32 v5, 4, v2
    s_mul_i32 s15, s2, 3136
    s_mul_i32 s16, s14, 320
    s_add_u32 s15, s15, s16
    s_lshl_b32 s17, s15, 2
    s_lshl_b32 s18, s15, 3
    s_lshl_b32 s19, s15, 5
    s_waitcnt lgkmcnt(0)
    s_add_u32 s6, s6, s17
    s_addc_u32 s7, s7, 0
    global_load_dword v10, v3, s[6:7] offset:0 nt
    global_load_dword v11, v3, s[6:7] offset:256 nt
    global_load_dword v12, v3, s[6:7] offset:512 nt
    global_load_dword v13, v3, s[6:7] offset:768 nt
    s_add_u32 s4, s4, s17
    s_addc_u32 s5, s5, 0
    global_load_dword v15, v3, s[4:5] offset:0 nt
    global_load_dword v16, v3, s[4:5] offset:256 nt
    global_load_dword v17, v3, s[4:5] offset:512 nt
    global_load_dword v18, v3, s[4:5] offset:768 nt
    s_add_u32 s8, s8, s18
    s_addc_u32 s9, s9, 0
    global_load_dwordx2 v[20:21], v4, s[8:9] offset:0 nt
    global_load_dwordx2 v[22:23], v4, s[8:9] offset:512 nt
    global_load_dwordx2 v[24:25], v4, s[8:9] offset:1024 nt
    global_load_dwordx2 v[26:27], v4, s[8:9] offset:1536 nt
    s_barrier
    s_add_u32 s10, s10, s19
    s_addc_u32 s11, s11, 0
    s_lshl_b32 s20, s16, 5
    s_add_u32 s20, s20, 53248
    s_add_u32 m0, s20, 0
    v_add_u32 v6, 0, v5
    global_load_lds_dwordx4 v6, s[10:11] offset:0 nt
    global_load_lds_dwordx4 v6, s[10:11] offset:1024 nt
    global_load_lds_dwordx4 v6, s[10:11] offset:2048 nt
    global_load_lds_dwordx4 v6, s[10:11] offset:3072 nt
    s_add_u32 m0, s20, 4096
    v_add_u32 v6, 4096, v5
    global_load_lds_dwordx4 v6, s[10:11] offset:0 nt
    global_load_lds_dwordx4 v6, s[10:11] offset:1024 nt
    global_load_lds_dwordx4 v6, s[10:11] offset:2048 nt
    global_load_lds_dwordx4 v6, s[10:11] offset:3072 nt
    s_mov_b32 s21, 42800
    s_mov_b32 s22, -98
    v_mov_b32 v7, 1
    s_waitcnt vmcnt(16)
    v_mul_u32_u24 v30, s21, v10
    v_lshrrev_b32 v30, 22, v30
    v_mad_i32_i24 v10, v30, s22, v10
    v_lshlrev_b32 v30, 2, v30
    ds_add_rtn_u32 v35, v30, v7 offset:0
    v_mul_u32_u24 v31, s21, v11
    v_lshrrev_b32 v31, 22, v31
    v_mad_i32_i24 v11, v31, s22, v11
    v_lshlrev_b32 v31, 2, v31
    ds_add_rtn_u32 v36, v31, v7 offset:0
    v_mul_u32_u24 v32, s21, v12
    v_lshrrev_b32 v32, 22, v32
    v_mad_i32_i24 v12, v32, s22, v12
    v_lshlrev_b32 v32, 2, v32
    ds_add_rtn_u32 v37, v32, v7 offset:0
    v_mul_u32_u24 v33, s21, v13
    v_lshrrev_b32 v33, 22, v33
    v_mad_i32_i24 v13, v33, s22, v13
    v_lshlrev_b32 v33, 2, v33
    ds_add_rtn_u32 v38, v33, v7 offset:0
    s_waitcnt lgkmcnt(0)
    s_barrier
    ds_read_b128 v[40:43], v5 offset:0
    s_waitcnt vmcnt(8)
    v_lshlrev_b32 v10, 2, v10
    v_lshl_or_b32 v15, v15, 17, v10
    v_lshlrev_b32 v11, 2, v11
    v_lshl_or_b32 v16, v16, 17, v11
    v_lshlrev_b32 v12, 2, v12
    v_lshl_or_b32 v17, v17, 17, v12
    v_lshlrev_b32 v13, 2, v13
    v_lshl_or_b32 v18, v18, 17, v13
    v_lshl_add_u32 v53, v2, 5, s20
    s_waitcnt lgkmcnt(0)
    v_add_u32 v44, v40, v41
    v_add_u32 v45, v44, v42
    v_add_u32 v47, v45, v43
    v_mov_b32 v46, v47
    v_add_u32 v54, 2048, v53
    s_nop 0
    v_add_u32_dpp v46, v46, v46 row_shr:1 row_mask:0xf bank_mask:0xf
    v_add_u32 v55, 4096, v53
    s_nop 0
    v_add_u32_dpp v46, v46, v46 row_shr:2 row_mask:0xf bank_mask:0xf
    v_add_u32 v56, 6144, v53
    s_nop 0
    v_add_u32_dpp v46, v46, v46 row_shr:4 row_mask:0xf bank_mask:0xf
    s_nop 1
    v_add_u32_dpp v46, v46, v46 row_shr:8 row_mask:0xf bank_mask:0xf
    s_nop 1
    v_add_u32_dpp v46, v46, v46 row_bcast:15 row_mask:0xa bank_mask:0xf
    s_nop 1
    v_add_u32_dpp v46, v46, v46 row_bcast:31 row_mask:0xc bank_mask:0xf
    v_sub_u32 v46, v46, v47
    v_add_u32 v41, v46, v40
    v_add_u32 v42, v46, v44
    v_add_u32 v43, v46, v45
    v_mov_b32 v40, v46
    ds_write_b128 v5, v[40:43] offset:1024
    ds_read_b32 v30, v30 offset:1024
    ds_read_b32 v31, v31 offset:1024
    ds_read_b32 v32, v32 offset:1024
    ds_read_b32 v33, v33 offset:1024
    s_mov_b32 s23, 14848
    s_waitcnt lgkmcnt(3)
    v_add_u32 v30, v30, v35
    v_lshlrev_b32 v35, 2, v30
    v_mad_u32_u24 v30, v30, 12, s23
    ds_write_b32 v35, v53 offset:2048
    ds_write_b32 v30, v15
    ds_write2_b32 v30, v20, v21 offset0:1 offset1:2
    s_waitcnt lgkmcnt(5)
    v_add_u32 v31, v31, v36
    v_lshlrev_b32 v36, 2, v31
    v_mad_u32_u24 v31, v31, 12, s23
    ds_write_b32 v36, v54 offset:2048
    ds_write_b32 v31, v16
    ds_write2_b32 v31, v22, v23 offset0:1 offset1:2
    s_waitcnt lgkmcnt(7)
    v_add_u32 v32, v32, v37
    v_lshlrev_b32 v37, 2, v32
    v_mad_u32_u24 v32, v32, 12, s23
    ds_write_b32 v37, v55 offset:2048
    ds_write_b32 v32, v17
    ds_write2_b32 v32, v24, v25 offset0:1 offset1:2
    s_waitcnt lgkmcnt(9)
    v_add_u32 v33, v33, v38
    v_lshlrev_b32 v38, 2, v33
    v_mad_u32_u24 v33, v33, 12, s23
    ds_write_b32 v38, v56 offset:2048
    ds_write_b32 v33, v18
    ds_write2_b32 v33, v26, v27 offset0:1 offset1:2
    s_mul_i32 s23, s14, 3840
    v_add_u32 v8, s23, v5
    v_lshrrev_b32 v9, 1, v2
    v_add_lshl_u32 v9, v9, s16, 2
    s_mul_i32 s23, s2, 37632
    s_add_u32 s23, s23, 1048576
    s_add_u32 s26, s12, s23
    s_addc_u32 s27, s13, 0
    s_add_u32 s19, s19, 11534336
    s_add_u32 s28, s12, s19
    s_addc_u32 s29, s13, 0
    v_and_b32 v10, 1, v2
    v_lshlrev_b32 v10, 4, v10
    v_add_u32 v6, 4096, v5
    v_add_u32 v7, 8192, v5
    s_waitcnt lgkmcnt(0)
    s_barrier
    ds_read_b128 v[12:15], v8 offset:14848
    ds_read_b128 v[16:19], v8 offset:15872
    ds_read_b128 v[20:23], v8 offset:16896
    ds_read_b32 v30, v9 offset:2048
    ds_read_b32 v31, v9 offset:2176
    ds_read_b32 v32, v9 offset:2304
    ds_read_b32 v33, v9 offset:2432
    ds_read_b32 v34, v9 offset:2560
    ds_read_b32 v35, v9 offset:2688
    ds_read_b32 v36, v9 offset:2816
    ds_read_b32 v37, v9 offset:2944
    s_waitcnt lgkmcnt(10)
    global_store_dwordx4 v8, v[12:15], s[26:27] offset:0 sc1
    s_waitcnt lgkmcnt(9)
    global_store_dwordx4 v8, v[16:19], s[26:27] offset:1024 sc1
    s_waitcnt lgkmcnt(8)
    global_store_dwordx4 v8, v[20:23], s[26:27] offset:2048 sc1
    s_mov_b64 exec, -1
    s_waitcnt lgkmcnt(0)
    v_add_u32 v30, v30, v10
    v_add_u32 v31, v31, v10
    v_add_u32 v32, v32, v10
    v_add_u32 v33, v33, v10
    v_add_u32 v34, v34, v10
    v_add_u32 v35, v35, v10
    v_add_u32 v36, v36, v10
    v_add_u32 v37, v37, v10
    s_waitcnt vmcnt(0)
    s_barrier
    ds_read_b128 v[40:43], v30
    ds_read_b128 v[44:47], v31
    ds_read_b128 v[48:51], v32
    ds_read_b128 v[52:55], v33
    ds_read_b128 v[56:59], v34
    ds_read_b128 v[60:63], v35
    ds_read_b128 v[64:67], v36
    ds_read_b128 v[68:71], v37
    s_waitcnt lgkmcnt(7)
    global_store_dwordx4 v5, v[40:43], s[28:29] offset:0 sc1
    s_waitcnt lgkmcnt(6)
    global_store_dwordx4 v5, v[44:47], s[28:29] offset:1024 sc1
    s_waitcnt lgkmcnt(5)
    global_store_dwordx4 v5, v[48:51], s[28:29] offset:2048 sc1
    s_waitcnt vmcnt(2) lgkmcnt(4)
    global_store_dwordx4 v5, v[52:55], s[28:29] offset:3072 sc1
    s_waitcnt vmcnt(2) lgkmcnt(3)
    global_store_dwordx4 v6, v[56:59], s[28:29] offset:0 sc1
    s_waitcnt vmcnt(2) lgkmcnt(2)
    global_store_dwordx4 v6, v[60:63], s[28:29] offset:1024 sc1
    s_waitcnt vmcnt(2) lgkmcnt(1)
    global_store_dwordx4 v6, v[64:67], s[28:29] offset:2048 sc1
    s_waitcnt vmcnt(2) lgkmcnt(0)
    global_store_dwordx4 v6, v[68:71], s[28:29] offset:3072 sc1
    s_branch Ljoin
Lprep:
    s_load_dwordx4 s[4:7], s[0:1], 40
    s_load_dwordx2 s[8:9], s[0:1], 56
    s_load_dwordx2 s[12:13], s[0:1], 80
    s_lshr_b32 s14, s14, 6
    s_sub_u32 s14, s14, 1
    v_and_b32 v2, 63, v0
    v_lshlrev_b32 v5, 4, v2
    s_waitcnt lgkmcnt(0)
    s_add_u32 s12, s12, 262144
    s_addc_u32 s13, s13, 0
    s_cmp_ge_u32 s14, 8
    s_cbranch_scc1 Lprep2
    s_lshr_b32 s15, s14, 1
    s_and_b32 s16, s14, 1
    s_lshl_b32 s15, s15, 11
    s_lshl_b32 s16, s16, 1
    s_add_u32 s15, s15, s16
    v_lshrrev_b32 v3, 5, v2
    v_lshlrev_b32 v3, 10, v3
    v_and_b32 v4, 31, v2
    v_lshl_add_u32 v3, v4, 2, v3
    v_add_u32 v3, s15, v3
    s_lshl_b32 s17, s14, 10
    s_add_u32 s17, s17, 4096
    global_load_ushort v10, v3, s[8:9] offset:0
    global_load_ushort v11, v3, s[8:9] offset:128
    global_load_ushort v12, v3, s[8:9] offset:256
    global_load_ushort v13, v3, s[8:9] offset:384
    global_load_ushort v14, v3, s[8:9] offset:512
    global_load_ushort v15, v3, s[8:9] offset:640
    global_load_ushort v16, v3, s[8:9] offset:768
    global_load_ushort v17, v3, s[8:9] offset:896
    s_waitcnt vmcnt(0)
    v_lshl_or_b32 v20, v11, 16, v10
    v_lshl_or_b32 v21, v13, 16, v12
    v_lshl_or_b32 v22, v15, 16, v14
    v_lshl_or_b32 v23, v17, 16, v16
    v_add_u32 v6, s17, v5
    global_store_dwordx4 v6, v[20:23], s[12:13] sc1
    s_branch Lprep3
Lprep2:
    s_mov_b32 s14, 0
Lprep4:
    s_lshl_b32 s17, s14, 10
    v_lshl_add_u32 v3, v2, 1, s17
    global_load_ushort v10, v3, s[6:7] offset:0
    global_load_ushort v11, v3, s[6:7] offset:128
    global_load_ushort v12, v3, s[6:7] offset:256
    global_load_ushort v13, v3, s[6:7] offset:384
    global_load_ushort v14, v3, s[6:7] offset:512
    global_load_ushort v15, v3, s[6:7] offset:640
    global_load_ushort v16, v3, s[6:7] offset:768
    global_load_ushort v17, v3, s[6:7] offset:896
    s_waitcnt vmcnt(0)
    v_lshl_or_b32 v20, v11, 16, v10
    v_lshl_or_b32 v21, v13, 16, v12
    v_lshl_or_b32 v22, v15, 16, v14
    v_lshl_or_b32 v23, v17, 16, v16
    v_add_u32 v6, s17, v5
    global_store_dwordx4 v6, v[20:23], s[12:13] sc1
    s_lshl_b32 s15, s14, 6
    v_and_b32 v3, 3, v2
    v_lshl_add_u32 v3, v3, 1, s15
    s_add_u32 s17, s17, 2048
    global_load_ushort v10, v3, s[4:5] offset:0
    global_load_ushort v11, v3, s[4:5] offset:8
    global_load_ushort v12, v3, s[4:5] offset:16
    global_load_ushort v13, v3, s[4:5] offset:24
    global_load_ushort v14, v3, s[4:5] offset:32
    global_load_ushort v15, v3, s[4:5] offset:40
    global_load_ushort v16, v3, s[4:5] offset:48
    global_load_ushort v17, v3, s[4:5] offset:56
    s_waitcnt vmcnt(0)
    v_lshl_or_b32 v20, v11, 16, v10
    v_lshl_or_b32 v21, v13, 16, v12
    v_lshl_or_b32 v22, v15, 16, v14
    v_lshl_or_b32 v23, v17, 16, v16
    v_add_u32 v6, s17, v5
    global_store_dwordx4 v6, v[20:23], s[12:13] sc1
    s_add_u32 s14, s14, 1
    s_cmp_lt_u32 s14, 2
    s_cbranch_scc1 Lprep4
    s_branch Lprep3
Lspare:
    s_cmp_ge_u32 s14, 960
    s_cbranch_scc1 Lw15
Lprep3:
    s_waitcnt vmcnt(0)
    s_barrier
    s_barrier
    s_barrier
    s_barrier
    s_branch Ljoin
Lw15:
    s_setprio 3
    s_load_dwordx2 s[12:13], s[0:1], 80
    s_load_dwordx2 s[4:5], s[0:1], 72
    v_and_b32 v2, 63, v0
    s_and_b32 s15, s2, 7
    s_lshl_b32 s15, s15, 5
    s_lshr_b32 s16, s2, 3
    s_add_u32 s15, s15, s16
    s_lshl_b32 s15, s15, 2
    v_lshl_add_u32 v14, v2, 12, s15
    s_lshl_b32 s16, s2, 4
    s_add_u32 s16, s16, 327680
    v_mov_b32 v3, s16
    v_mov_b32 v4, -1
    v_mov_b32 v5, -1
    v_mov_b32 v6, -1
    v_mov_b32 v7, -1
    v_mov_b32 v24, 0
    v_mov_b32 v25, 0
    v_mov_b32 v26, 0
    v_mov_b32 v27, 0
    s_and_b32 s16, s2, 3
    s_lshl_b32 s16, s16, 6
    v_mov_b32 v9, s16
    v_mov_b32 v10, 1
    v_lshlrev_b32 v11, 2, v2
    v_lshlrev_b32 v12, 4, v2
    s_and_b32 s16, s2, 0
    s_sub_u32 s17, s2, s16
    s_lshl_b32 s17, s17, 10
    s_mul_i32 s16, s16, 128
    s_add_u32 s17, s17, s16
    v_and_b32 v1, 127, v12
    v_sub_u32 v8, v12, v1
    v_mad_u32_u24 v1, v8, 1, v1
    v_add_u32 v1, s17, v1
    v_mov_b32 v15, 156672
    ds_write_b128 v15, v[24:27]
    ds_write_b128 v12, v[24:27] offset:0
    s_mov_b32 s10, 262144
    s_mov_b32 s11, 0x20000
    s_waitcnt lgkmcnt(0)
    s_mov_b32 s8, s12
    s_mov_b32 s9, s13
    global_store_dwordx4 v1, v[4:7], s[12:13] sc1
    s_mov_b64 exec, 1
    global_store_dword v3, v4, s[12:13] sc1
    s_cmp_eq_u32 s2, 255
    s_cbranch_scc1 Lw15_1
    s_barrier
Lw15_1:
    s_waitcnt vmcnt(0)
    global_atomic_add v9, v10, s[4:5] sc1
    s_cbranch_scc0 Lw15_2
    s_barrier
Lw15_2:
    s_mov_b64 exec, -1
    s_mov_b32 s17, 400000
    s_barrier
    ds_read_b128 v[16:19], v12 offset:0
    s_mul_i32 s16, s2, 3136
    s_waitcnt lgkmcnt(0)
    v_add_u32 v20, v16, v17
    v_add_u32 v21, v20, v18
    v_add_u32 v23, v21, v19
    v_mov_b32 v22, v23
    s_nop 1
    v_add_u32_dpp v22, v22, v22 row_shr:1 row_mask:0xf bank_mask:0xf
    s_nop 1
    v_add_u32_dpp v22, v22, v22 row_shr:2 row_mask:0xf bank_mask:0xf
    s_nop 1
    v_add_u32_dpp v22, v22, v22 row_shr:4 row_mask:0xf bank_mask:0xf
    s_nop 1
    v_add_u32_dpp v22, v22, v22 row_shr:8 row_mask:0xf bank_mask:0xf
    s_nop 1
    v_add_u32_dpp v22, v22, v22 row_bcast:15 row_mask:0xa bank_mask:0xf
    s_nop 1
    v_add_u32_dpp v22, v22, v22 row_bcast:31 row_mask:0xc bank_mask:0xf
    v_sub_u32 v22, v22, v23
    v_add_u32 v22, s16, v22
    v_add_u32 v25, v22, v16
    v_add_u32 v26, v22, v20
    v_add_u32 v27, v22, v21
    v_lshl_or_b32 v24, v16, 20, v22
    v_lshl_or_b32 v25, v17, 20, v25
    v_lshl_or_b32 v26, v18, 20, v26
    v_lshl_or_b32 v27, v19, 20, v27
    s_barrier
    s_barrier
    global_store_dwordx4 v1, v[24:27], s[12:13] sc1
    s_branch Lw15_poll0
Lw15_poll:
    s_sleep 16
Lw15_poll0:
    global_load_dword v13, v11, s[4:5] sc1
    s_sub_u32 s17, s17, 1
    s_cbranch_scc1 Lend
    s_waitcnt vmcnt(0)
    v_readlane_b32 s18, v13, 0
    v_readlane_b32 s19, v13, 16
    v_readlane_b32 s20, v13, 32
    v_readlane_b32 s21, v13, 48
Lw15_sum:
    s_add_u32 s18, s18, s19
    s_add_u32 s20, s20, s21
    s_add_u32 s18, s18, s20
    s_cmp_lt_u32 s18, 256
    s_cbranch_scc1 Lw15_poll
Lw15_cdone:
    s_cmp_eq_u32 s2, 255
    s_cbranch_scc1 Lw15_n
Lw15_k:
    s_sleep 2
    ds_read_b32 v22, v15 offset:8
    s_waitcnt lgkmcnt(0)
    v_readfirstlane_b32 s18, v22
    s_cmp_lt_u32 s18, 1
    s_cbranch_scc1 Lw15_k
Lw15_c:
    buffer_load_dword v16, v14, s[8:11], 0 offen offset:0 sc1
    buffer_load_dword v17, v14, s[8:11], 0 offen offset:1024 sc1
    buffer_load_dword v18, v14, s[8:11], 0 offen offset:2048 sc1
    buffer_load_dword v19, v14, s[8:11], 0 offen offset:3072 sc1
Lw15_col:
    s_waitcnt vmcnt(0)
    v_max_u32 v20, v16, v17
    v_max3_u32 v20, v18, v19, v20
    v_cmp_eq_u32 vcc, -1, v20
    s_and_b64 exec, exec, vcc
    s_cbranch_scc0 Lw15_e
    s_sleep 4
    buffer_load_dword v16, v14, s[8:11], 0 offen offset:0 sc1
    buffer_load_dword v17, v14, s[8:11], 0 offen offset:1024 sc1
    buffer_load_dword v18, v14, s[8:11], 0 offen offset:2048 sc1
    buffer_load_dword v19, v14, s[8:11], 0 offen offset:3072 sc1
    s_sub_u32 s17, s17, 1
    s_cbranch_scc0 Lw15_col
    s_endpgm
Lw15_n:
    global_load_dword v13, v3, s[12:13] offset:-128 sc1
    s_sub_u32 s17, s17, 1
    s_cbranch_scc1 Lend
    s_waitcnt vmcnt(0)
    v_cmp_eq_u32 vcc, 0, v13
    s_cbranch_vccnz Lw15_c
    s_sleep 16
    s_branch Lw15_n
Lw15_e:
    s_mov_b64 exec, -1
    v_add_u32 v12, 155648, v12
    v_lshlrev_b32 v13, 3, v2
    v_mov_b32 v20, 0
    v_mov_b32 v21, 0
    ds_write_b128 v12, v[16:19]
    ds_write_b64 v13, v[20:21] offset:49152
    ds_write_b32 v15, v10
    s_setprio 0
    s_waitcnt lgkmcnt(0)
Ljoin:
    s_load_dwordx2 s[14:15], s[0:1], 80
    s_load_dwordx2 s[4:5], s[0:1], 0
    s_load_dwordx2 s[6:7], s[0:1], 64
    v_lshrrev_b32 v81, 6, v0
    v_and_b32 v18, 63, v0
    v_readfirstlane_b32 s24, v81
    s_and_b32 s25, s2, 7
    s_lshl_b32 s25, s25, 5
    s_lshr_b32 s58, s2, 3
    s_add_u32 s25, s25, s58
    v_lshlrev_b32 v81, 4, v18
    s_mov_b32 s18, 262144
    s_mov_b32 s19, 0x20000
    s_mov_b32 s27, 0
    s_mov_b32 s28, 3552
    s_mov_b32 s35, 1
    s_mov_b32 s41, 1
    s_mov_b32 s40, 6
    s_mov_b32 s56, 0x0f0f0f0f
    s_mov_b32 s57, 0xf0f0f0f0
    s_mov_b32 s42, 0xc000
    s_mul_i32 s30, s24, 3072
    s_lshl_b32 s43, s24, 11
    s_add_u32 s43, s43, 50176
    v_and_b32 v6, 1, v18
    v_and_b32 v19, 0x3c1, v0
    v_bfe_u32 v82, v18, 1, 1
    v_lshl_add_u32 v19, v82, 5, v19
    v_lshrrev_b32 v82, 2, v18
    v_lshl_add_u32 v19, v82, 1, v19
    v_lshlrev_b32 v6, 4, v6
    v_mov_b32 v96, 0
    v_mov_b32 v97, 0
    v_mov_b32 v98, 0
    v_mov_b32 v99, 0
    v_mov_b32 v100, 0
    v_mov_b32 v101, 0
    v_mov_b32 v102, 0
    v_mov_b32 v103, 0
    v_mov_b32 v104, 0
    v_mov_b32 v105, 0
    v_mov_b32 v106, 0
    v_mov_b32 v107, 0
    v_mov_b32 v108, 0
    v_mov_b32 v109, 0
    v_mov_b32 v110, 0
    v_mov_b32 v111, 0
    v_mov_b32 v112, 0
    v_mov_b32 v113, 0
    v_mov_b32 v114, 0
    v_mov_b32 v115, 0
    v_mov_b32 v116, 0
    v_mov_b32 v117, 0
    v_mov_b32 v118, 0
    v_mov_b32 v119, 0
    v_mov_b32 v120, 0
    v_mov_b32 v121, 0
    v_mov_b32 v122, 0
    v_mov_b32 v123, 0
    v_mov_b32 v124, 0
    v_mov_b32 v125, 0
    v_mov_b32 v126, 0
    v_mov_b32 v127, 0
    s_waitcnt lgkmcnt(0)
    s_mov_b32 s16, s14
    s_mov_b32 s17, s15
    s_add_u32 s12, s14, 262144
    s_addc_u32 s13, s15, 0
    s_add_u32 s8, s14, 1048576
    s_addc_u32 s9, s15, 0
    s_add_u32 s10, s14, 11534336
    s_addc_u32 s11, s15, 0
    s_mov_b32 s20, s6
    s_mov_b32 s21, s7
    s_mov_b32 s22, 12800000
    s_mov_b32 s23, 0x20000
    s_cmp_ge_u32 s24, 10
    s_cbranch_scc1 Lhelper
    v_mov_b32 v82, 156676
    v_mov_b32 v83, 1
    s_lshl_b32 s58, s2, 4
    s_add_u32 s58, s58, 327680
    v_mov_b32 v84, s58
    v_mov_b32 v85, 0
    s_mov_b64 exec, 1
    s_waitcnt vmcnt(0)
    ds_add_rtn_u32 v83, v82, v83
    s_waitcnt lgkmcnt(0)
    v_readfirstlane_b32 s58, v83
    s_cmp_lg_u32 s58, 9
    s_cbranch_scc1 Lnoflag
    global_store_dword v84, v85, s[14:15] sc1
Lnoflag:
    s_mov_b64 exec, -1
    s_branch Lgo
Lhelper:
    s_cmp_lt_u32 s24, 15
    s_cbranch_scc1 Lexpand
    v_lshlrev_b32 v77, 1, v18
    v_sub_u32 v78, 0x7f, v77
    v_sub_u32 v79, 0x7e, v77
    v_lshlrev_b32 v77, 2, v77
    v_mov_b32 v82, 0x7f000000
    v_mov_b32 v83, 0x7f000000
    ds_write_b64 v77, v[78:79] offset:0
    ds_write_b64 v77, v[82:83] offset:49664
    s_branch Lgo
Lexpand:
    v_mov_b32 v82, 156672
    s_mov_b32 s59, 3200000
Lwtab:
    ds_read_b32 v76, v82
    s_sub_u32 s59, s59, 1
    s_cbranch_scc1 Lend
    s_waitcnt lgkmcnt(0)
    v_readfirstlane_b32 s58, v76
    s_cmp_lg_u32 s58, 0
    s_cbranch_scc1 Lwtabd
    s_sleep 2
    s_branch Lwtab
Lwtabd:
    v_add_u32 v82, 155648, v81
    ds_read_b128 v[52:55], v82
    s_waitcnt lgkmcnt(0)
Lhavetab:
    s_sub_u32 s60, s24, 10
    v_lshrrev_b32 v56, 20, v52
    v_lshrrev_b32 v57, 20, v53
    v_lshrrev_b32 v58, 20, v54
    v_lshrrev_b32 v59, 20, v55
    v_add_u32 v76, v56, v57
    v_add_u32 v77, v76, v58
    v_add_u32 v79, v77, v59
    v_mov_b32 v78, v79
    v_and_b32 v60, 0xfffff, v52
    s_nop 0
    v_add_u32_dpp v78, v78, v78 row_shr:1 row_mask:0xf bank_mask:0xf
    v_and_b32 v61, 0xfffff, v53
    s_nop 0
    v_add_u32_dpp v78, v78, v78 row_shr:2 row_mask:0xf bank_mask:0xf
    v_and_b32 v62, 0xfffff, v54
    s_nop 0
    v_add_u32_dpp v78, v78, v78 row_shr:4 row_mask:0xf bank_mask:0xf
    v_and_b32 v63, 0xfffff, v55
    s_nop 0
    v_add_u32_dpp v78, v78, v78 row_shr:8 row_mask:0xf bank_mask:0xf
    s_nop 1
    v_add_u32_dpp v78, v78, v78 row_bcast:15 row_mask:0xa bank_mask:0xf
    s_nop 1
    v_add_u32_dpp v78, v78, v78 row_bcast:31 row_mask:0xc bank_mask:0xf
    v_sub_u32 v64, v78, v79
    v_readlane_b32 s26, v78, 63
    v_add_u32 v65, v64, v56
    v_add_u32 v66, v64, v76
    v_add_u32 v67, v64, v77
    s_sub_u32 s29, s26, s27
    s_min_u32 s29, s29, s28
    s_cmp_lg_u32 s29, s26
    s_cbranch_scc1 Lclip
Lnoclip:
    v_max_u32 v80, v56, v57
    v_max3_u32 v80, v58, v59, v80
    v_sub_u32 v60, v60, v64
    v_add_lshl_u32 v64, v64, s60, 2
    v_sub_u32 v61, v61, v65
    v_add_lshl_u32 v65, v65, s60, 2
    v_sub_u32 v62, v62, v66
    v_add_lshl_u32 v66, v66, s60, 2
    v_sub_u32 v63, v63, v67
    v_add_lshl_u32 v67, v67, s60, 2
Lexp:
    v_cmp_lt_u32 s[48:49], s60, v56
    v_cmp_lt_u32 s[50:51], s60, v57
    v_cmp_lt_u32 s[52:53], s60, v58
    v_cmp_lt_u32 s[54:55], s60, v59
    s_add_u32 s60, s60, 5
    v_cmp_lt_u32 vcc, s60, v80
    s_mov_b64 exec, s[48:49]
    ds_write_b32 v64, v60 offset:14848
    s_mov_b64 exec, s[50:51]
    ds_write_b32 v65, v61 offset:14848
    s_mov_b64 exec, s[52:53]
    ds_write_b32 v66, v62 offset:14848
    s_mov_b64 exec, s[54:55]
    ds_write_b32 v67, v63 offset:14848
    s_mov_b64 exec, -1
    s_cbranch_vccz Lexpdone
    v_cmp_lt_u32 s[48:49], s60, v56
    v_cmp_lt_u32 s[50:51], s60, v57
    v_cmp_lt_u32 s[52:53], s60, v58
    v_cmp_lt_u32 s[54:55], s60, v59
    s_add_u32 s60, s60, 5
    v_cmp_lt_u32 vcc, s60, v80
    s_mov_b64 exec, s[48:49]
    ds_write_b32 v64, v60 offset:14868
    s_mov_b64 exec, s[50:51]
    ds_write_b32 v65, v61 offset:14868
    s_mov_b64 exec, s[52:53]
    ds_write_b32 v66, v62 offset:14868
    s_mov_b64 exec, s[54:55]
    ds_write_b32 v67, v63 offset:14868
    s_mov_b64 exec, -1
    s_cbranch_vccz Lexpdone
    v_cmp_lt_u32 s[48:49], s60, v56
    v_cmp_lt_u32 s[50:51], s60, v57
    v_cmp_lt_u32 s[52:53], s60, v58
    v_cmp_lt_u32 s[54:55], s60, v59
    s_add_u32 s60, s60, 5
    v_cmp_lt_u32 vcc, s60, v80
    s_mov_b64 exec, s[48:49]
    ds_write_b32 v64, v60 offset:14888
    s_mov_b64 exec, s[50:51]
    ds_write_b32 v65, v61 offset:14888
    s_mov_b64 exec, s[52:53]
    ds_write_b32 v66, v62 offset:14888
    s_mov_b64 exec, s[54:55]
    ds_write_b32 v67, v63 offset:14888
    s_mov_b64 exec, -1
    s_cbranch_vccz Lexpdone
    s_waitcnt lgkmcnt(0)
    v_add_u32 v64, 60, v64
    v_add_u32 v65, 60, v65
    v_add_u32 v66, 60, v66
    v_add_u32 v67, 60, v67
    s_branch Lexp
Lexpdone:
    v_mov_b32 v76, 0
    v_mov_b32 v77, s26
    ds_write_b32 v76, v77 offset:49652
Lgo:
    v_lshlrev_b32 v7, 2, v19
    v_mov_b32 v8, 0
    v_add_u32 v84, 0, v19
    v_add_u32 v85, 1024, v19
    v_add_u32 v86, 2048, v19
    v_add_u32 v87, 3072, v19
    s_waitcnt lgkmcnt(0)
    s_barrier
    ds_read_b32 v8, v8 offset:49652
    ds_read_b32 v95, v7 offset:27136
    ds_read_b32 v92, v7 offset:14848
    ds_read_b32 v93, v7 offset:18944
    ds_read_b32 v94, v7 offset:23040
    s_sub_u32 s60, s24, 10
    s_cmp_ge_u32 s60, 4
    s_cbranch_scc1 Lnoc
    s_mov_b32 m0, s30
    s_lshl_b32 s58, s60, 10
    v_add_u32 v82, s58, v81
    global_load_lds_dwordx4 v82, s[12:13] sc1
Lnoc:
    s_waitcnt lgkmcnt(4)
    v_readfirstlane_b32 s26, v8
    s_sub_u32 s29, s26, s27
    s_min_u32 s29, s29, s28
    v_cmp_gt_u32 s[54:55], s29, v87
    v_cmp_gt_u32 s[48:49], s29, v84
    v_cmp_gt_u32 s[50:51], s29, v85
    v_cmp_gt_u32 s[52:53], s29, v86
    s_waitcnt lgkmcnt(3)
    v_add_u32 v95, v95, v87
    v_cndmask_b32 v95, 0, v95, s[54:55]
    v_mul_u32_u24 v91, 12, v95
    s_cmp_eq_u64 s[54:55], 0
    s_cbranch_scc1 Ls3a
    global_load_dwordx3 v[40:42], v91, s[8:9] sc1
Ls3a:
    s_waitcnt lgkmcnt(2)
    v_add_u32 v92, v92, v84
    v_cndmask_b32 v92, 0, v92, s[48:49]
    v_mul_u32_u24 v88, 12, v92
    global_load_dwordx3 v[28:30], v88, s[8:9] sc1
    s_waitcnt lgkmcnt(1)
    v_add_u32 v93, v93, v85
    v_cndmask_b32 v93, 0, v93, s[50:51]
    v_mul_u32_u24 v89, 12, v93
    global_load_dwordx3 v[32:34], v89, s[8:9] sc1
    s_waitcnt lgkmcnt(0)
    v_add_u32 v94, v94, v86
    v_cndmask_b32 v94, 0, v94, s[52:53]
    v_mul_u32_u24 v90, 12, v94
    global_load_dwordx3 v[36:38], v90, s[8:9] sc1
    v_lshlrev_b32 v92, 5, v92
    v_lshlrev_b32 v93, 5, v93
    v_lshlrev_b32 v94, 5, v94
    v_lshlrev_b32 v95, 5, v95
    s_cmp_ge_u32 s24, 2
    s_cbranch_scc1 Lnort
    v_lshlrev_b32 v77, 2, v0
    v_subrev_u32 v52, 70, v0
    v_cmp_le_u32 vcc, 84, v0
    v_cmp_gt_u32 s[58:59], 14, v52
    v_subrev_u32 v79, 14, v0
    v_lshrrev_b32 v80, 1, v52
    v_cndmask_b32 v76, v0, v79, vcc
    v_mul_u32_u24 v79, 147, v76
    v_lshrrev_b32 v79, 11, v79
    v_mad_i32_i24 v76, v79, -14, v76
    v_and_b32 v53, 1, v79
    v_cmp_eq_u32 vcc, 1, v53
    v_sub_u32 v53, 13, v76
    v_xor_b32 v52, v52, v80
    v_and_or_b32 v52, v52, 1, 14
    v_cndmask_b32 v76, v76, v53, vcc
    v_cndmask_b32 v79, v79, v80, s[58:59]
    v_cndmask_b32 v76, v76, v52, s[58:59]
    v_mul_u32_u24 v52, 2100224, v76
    v_lshl_or_b32 v52, v79, 2, v52
    v_and_b32 v53, 1, v79
    v_lshl_add_u32 v52, v53, 20, v52
    v_lshrrev_b32 v79, 1, v79
    v_lshl_add_u32 v52, v79, 18, v52
    ds_write_b32 v77, v52 offset:512
Lnort:
    v_lshrrev_b32 v76, 3, v0
    v_lshlrev_b32 v15, 2, v76
    v_and_b32 v16, 7, v0
    v_lshlrev_b32 v16, 6, v16
    v_mov_b32 v17, 0x80
    v_lshl_add_u32 v82, v18, 2, s30
    v_mov_b32 v83, 0
    s_waitcnt vmcnt(0)
    v_and_b32 v31, 0x1fc, v28
    v_and_b32 v35, 0x1fc, v32
    v_and_b32 v39, 0x1fc, v36
    v_and_b32 v43, 0x1fc, v40
    s_cmp_eq_u32 s35, 0
    s_cbranch_scc1 Llatermap
    s_mov_b32 s35, 0
    s_mov_b64 exec, s[48:49]
    ds_add_u32 v31, v17 offset:0
    s_mov_b64 exec, s[50:51]
    ds_add_u32 v35, v17 offset:0
    s_mov_b64 exec, s[52:53]
    ds_add_u32 v39, v17 offset:0
    s_cmp_eq_u64 s[54:55], 0
    s_cbranch_scc1 Ls3r1
    s_mov_b64 exec, s[54:55]
    ds_add_u32 v43, v17 offset:0
Ls3r1:
    s_mov_b64 exec, -1
    s_cmp_eq_u32 s41, 0
    s_cbranch_scc1 LpolledB1
    s_mov_b32 s41, 0
    s_cmp_ge_u32 s24, 4
    s_cbranch_scc1 LpolledB1
    v_min_u32 v7, 255, v0
    v_lshlrev_b32 v7, 4, v7
    v_add_u32 v7, 327680, v7
    s_mov_b32 s61, 400000
Lflagpoll:
    global_load_dword v8, v7, s[14:15] sc1
    s_sub_u32 s61, s61, 1
    s_cbranch_scc1 Lend
    s_waitcnt vmcnt(0)
    v_cmp_ne_u32 vcc, 0, v8
    s_and_b64 exec, exec, vcc
    s_cbranch_scc1 Lflagpoll
    s_mov_b64 exec, -1
LpolledB1:
    s_waitcnt lgkmcnt(0)
    s_barrier
    ds_write_b32 v82, v83 offset:2784
    s_add_u32 m0, s43, 0
    v_add_u32_dpp v10, v92, v6 quad_perm:[0,0,1,1] row_mask:0xf bank_mask:0xf
    global_load_lds_dwordx4 v10, s[10:11] sc1
    s_add_u32 m0, s43, 1024
    v_add_u32_dpp v10, v92, v6 quad_perm:[2,2,3,3] row_mask:0xf bank_mask:0xf
    global_load_lds_dwordx4 v10, s[10:11] sc1
    s_cmp_ge_u32 s24, 13
    s_cbranch_scc1 Lnorank
    ds_read_b32 v77, v15 offset:0
    ds_read_b128 v[52:55], v16 offset:0
    ds_read_b128 v[56:59], v16 offset:16
    ds_read_b128 v[60:63], v16 offset:32
    ds_read_b128 v[68:71], v16 offset:48
    v_mov_b32 v78, 0
    v_cmp_gt_u32 vcc, 98, v76
    v_lshlrev_b32 v76, 9, v76
    s_waitcnt lgkmcnt(3)
    v_sub_u32 v52, v77, v52
    v_alignbit_b32 v78, v78, v52, 31
    v_sub_u32 v53, v77, v53
    v_alignbit_b32 v78, v78, v53, 31
    v_sub_u32 v54, v77, v54
    v_alignbit_b32 v78, v78, v54, 31
    v_sub_u32 v55, v77, v55
    v_alignbit_b32 v78, v78, v55, 31
    s_waitcnt lgkmcnt(2)
    v_sub_u32 v56, v77, v56
    v_alignbit_b32 v78, v78, v56, 31
    v_sub_u32 v57, v77, v57
    v_alignbit_b32 v78, v78, v57, 31
    v_sub_u32 v58, v77, v58
    v_alignbit_b32 v78, v78, v58, 31
    v_sub_u32 v59, v77, v59
    v_alignbit_b32 v78, v78, v59, 31
    s_waitcnt lgkmcnt(1)
    v_sub_u32 v60, v77, v60
    v_alignbit_b32 v78, v78, v60, 31
    v_sub_u32 v61, v77, v61
    v_alignbit_b32 v78, v78, v61, 31
    v_sub_u32 v62, v77, v62
    v_alignbit_b32 v78, v78, v62, 31
    v_sub_u32 v63, v77, v63
    v_alignbit_b32 v78, v78, v63, 31
    s_waitcnt lgkmcnt(0)
    v_sub_u32 v68, v77, v68
    v_alignbit_b32 v78, v78, v68, 31
    v_sub_u32 v69, v77, v69
    v_alignbit_b32 v78, v78, v69, 31
    v_sub_u32 v70, v77, v70
    v_alignbit_b32 v78, v78, v70, 31
    v_sub_u32 v71, v77, v71
    v_alignbit_b32 v78, v78, v71, 31
    v_bcnt_u32_b32 v78, v78, 0
    v_lshlrev_b32 v78, 2, v78
    s_nop 1
    v_add_u32_dpp v78, v78, v78 quad_perm:[1,0,3,2] row_mask:0xf bank_mask:0xf
    s_nop 1
    v_add_u32_dpp v78, v78, v78 quad_perm:[2,3,0,1] row_mask:0xf bank_mask:0xf
    s_nop 1
    v_add_u32_dpp v78, v78, v78 row_half_mirror row_mask:0xf bank_mask:0xf
    ds_read_b32 v78, v78 offset:512
    s_mov_b64 exec, vcc
    s_waitcnt lgkmcnt(0)
    v_lshrrev_b32 v79, 16, v78
    v_and_b32 v78, 0xffff, v78
    ds_write_b32 v79, v76 offset:49664
    ds_write_b32 v15, v78 offset:49152
    s_mov_b64 exec, -1
Lnorank:
    s_add_u32 m0, s43, 32768
    v_add_u32_dpp v10, v93, v6 quad_perm:[0,0,1,1] row_mask:0xf bank_mask:0xf
    global_load_lds_dwordx4 v10, s[10:11] sc1
Lhavemap:
    s_waitcnt lgkmcnt(0)
    s_barrier
    s_getreg_b32 s60, hwreg(20, 0, 3)
    s_mul_i32 s60, s60, 409600000
    ds_read_b32 v76, v31 offset:49152
    v_subrev_u32 v52, s60, v28
    v_lshrrev_b32 v52, 24, v52
    v_lshlrev_b32 v84, 5, v84
    ds_read_b32 v77, v35 offset:49152
    v_subrev_u32 v53, s60, v32
    v_lshrrev_b32 v53, 24, v53
    v_lshlrev_b32 v85, 5, v85
    ds_read_b32 v78, v39 offset:49152
    v_subrev_u32 v54, s60, v36
    v_lshrrev_b32 v54, 24, v54
    v_lshlrev_b32 v86, 5, v86
    s_cmp_eq_u64 s[54:55], 0
    s_cbranch_scc1 Ls3r2
    ds_read_b32 v79, v43 offset:49152
    v_subrev_u32 v55, s60, v40
    v_lshrrev_b32 v55, 24, v55
    v_lshlrev_b32 v87, 5, v87
Ls3r2:
    v_mov_b32 v83, 12
    s_mov_b32 s58, 252
    s_mov_b32 s59, 0xfffe0000
    s_waitcnt lgkmcnt(0)
    s_mov_b64 exec, s[48:49]
    v_bfi_b32 v31, s58, v52, v76
    ds_add_rtn_u32 v88, v31, v83 offset:2784
    v_bfi_b32 v84, 28, v76, v84
    v_bfi_b32 v28, s59, v28, v84
    s_mov_b64 exec, s[50:51]
    v_bfi_b32 v35, s58, v53, v77
    ds_add_rtn_u32 v89, v35, v83 offset:2784
    v_bfi_b32 v85, 28, v77, v85
    v_bfi_b32 v32, s59, v32, v85
    s_mov_b64 exec, s[52:53]
    v_bfi_b32 v39, s58, v54, v78
    ds_add_rtn_u32 v90, v39, v83 offset:2784
    v_bfi_b32 v86, 28, v78, v86
    v_bfi_b32 v36, s59, v36, v86
    s_cmp_eq_u64 s[54:55], 0
    s_cbranch_scc1 Ls3r3
    s_mov_b64 exec, s[54:55]
    v_bfi_b32 v43, s58, v55, v79
    ds_add_rtn_u32 v91, v43, v83 offset:2784
    v_bfi_b32 v87, 28, v79, v87
    v_bfi_b32 v40, s59, v40, v87
Ls3r3:
    s_mov_b64 exec, -1
    s_add_u32 m0, s43, 33792
    v_add_u32_dpp v10, v93, v6 quad_perm:[2,2,3,3] row_mask:0xf bank_mask:0xf
    global_load_lds_dwordx4 v10, s[10:11] sc1
    v_and_b32 v14, 63, v18
    v_lshl_add_u32 v14, v14, 2, s30
    v_mad_u32_u24 v17, v18, 12, s30
    s_waitcnt lgkmcnt(0)
    s_barrier
    ds_read_b32 v52, v14 offset:2784
    ds_read_b128 v[20:23], v81 offset:30720
    ds_read_b128 v[44:47], v81 offset:36864
    ds_read_b128 v[24:27], v81 offset:33792
    ds_read_b128 v[48:51], v81 offset:39936
    v_and_b32 v12, 3, v18
    v_bfe_u32 v13, v18, 2, 1
    v_lshl_add_u32 v12, v13, 3, v12
    v_bfe_u32 v13, v18, 3, 1
    v_lshl_add_u32 v12, v13, 2, v12
    v_bfe_u32 v13, v18, 4, 1
    v_mov_b32 v83, 28
    v_mov_b32 v54, 0
    s_waitcnt lgkmcnt(4)
    v_sub_u32 v53, s30, v52
    v_add_u32_dpp v52, v52, v52 row_shr:1 row_mask:0xf bank_mask:0xf
    v_lshl_add_u32 v12, v12, 1, v13
    v_mad_u32_u24 v12, v12, 12, s30
    v_add_u32_dpp v52, v52, v52 row_shr:2 row_mask:0xf bank_mask:0xf
    v_lshrrev_b32 v13, 2, v18
    v_and_b32 v15, 3, v18
    v_add_u32_dpp v52, v52, v52 row_shr:4 row_mask:0xf bank_mask:0xf
    v_lshl_add_u32 v13, v15, 4, v13
    v_mad_u32_u24 v13, v13, 12, s30
    v_add_u32_dpp v52, v52, v52 row_shr:8 row_mask:0xf bank_mask:0xf
    v_add_u32 v16, 1536, v13
    s_nop 0
    v_add_u32_dpp v52, v52, v52 row_bcast:15 row_mask:0xa bank_mask:0xf
    s_nop 1
    v_add_u32_dpp v52, v52, v52 row_bcast:31 row_mask:0xc bank_mask:0xf
    v_add_u32 v53, v53, v52
    v_readlane_b32 s31, v52, 63
    ds_write_b32 v14, v53 offset:2784
    s_cmp_gt_u32 s31, 2688
    s_cbranch_scc1 Lover
Loverb:
    v_add_u32 v17, s31, v17
    s_add_u32 s32, s31, 12
    s_mul_i32 s32, s32, 2731
    s_lshr_b32 s31, s32, 16
    s_min_u32 s33, s31, 3
    s_sub_u32 s32, s31, s33
    s_waitcnt lgkmcnt(0)
    s_barrier
    ds_read_b32 v54, v54 offset:49656
    ds_read_b32 v31, v31 offset:2784
    ds_read_b32 v35, v35 offset:2784
    ds_read_b32 v39, v39 offset:2784
    s_cmp_eq_u64 s[54:55], 0
    s_cbranch_scc1 Ls3r4
    ds_read_b32 v43, v43 offset:2784
Ls3r4:
    s_add_u32 m0, s43, 65536
    v_add_u32_dpp v10, v94, v6 quad_perm:[0,0,1,1] row_mask:0xf bank_mask:0xf
    global_load_lds_dwordx4 v10, s[10:11] sc1
    s_waitcnt lgkmcnt(0)
    v_cmp_ne_u32 vcc, 0, v54
    s_cbranch_vccnz Lslow
    s_mov_b64 exec, 63
    ds_write_b32 v17, v83
    s_mov_b64 exec, s[48:49]
    v_add_u32 v88, v88, v31
    ds_write_b32 v88, v28
    ds_write2_b32 v88, v29, v30 offset0:1 offset1:2
    s_mov_b64 exec, s[50:51]
    v_add_u32 v89, v89, v35
    ds_write_b32 v89, v32
    ds_write2_b32 v89, v33, v34 offset0:1 offset1:2
    s_mov_b64 exec, s[52:53]
    v_add_u32 v90, v90, v39
    ds_write_b32 v90, v36
    ds_write2_b32 v90, v37, v38 offset0:1 offset1:2
    s_cmp_eq_u64 s[54:55], 0
    s_cbranch_scc1 Ls3r5
    s_mov_b64 exec, s[54:55]
    v_add_u32 v91, v91, v43
    ds_write_b32 v91, v40
    ds_write2_b32 v91, v41, v42 offset0:1 offset1:2
Ls3r5:
    s_mov_b64 exec, -1
    s_add_u32 m0, s43, 66560
    v_add_u32_dpp v10, v94, v6 quad_perm:[2,2,3,3] row_mask:0xf bank_mask:0xf
    global_load_lds_dwordx4 v10, s[10:11] sc1
    s_cmp_eq_u64 s[54:55], 0
    s_cbranch_scc1 Ls3b
    s_add_u32 m0, s43, 98304
    v_add_u32_dpp v10, v95, v6 quad_perm:[0,0,1,1] row_mask:0xf bank_mask:0xf
    global_load_lds_dwordx4 v10, s[10:11] sc1
    s_add_u32 m0, s43, 99328
    v_add_u32_dpp v10, v95, v6 quad_perm:[2,2,3,3] row_mask:0xf bank_mask:0xf
    global_load_lds_dwordx4 v10, s[10:11] sc1
Ls3b:
    v_bfe_u32 v14, v18, 2, 2
    v_and_b32 v15, 3, v18
    v_lshrrev_b32 v9, 5, v18
    v_lshlrev_b32 v1, 7, v14
    v_lshl_add_u32 v1, v15, 4, v1
    v_lshrrev_b32 v2, 1, v1
    v_lshl_add_u32 v1, v9, 6, v1
    v_lshl_add_u32 v2, v9, 9, v2
    v_bfe_u32 v14, v18, 4, 1
    v_lshl_add_u32 v2, v14, 5, v2
    v_add_u32 v2, s30, v2
    s_waitcnt lgkmcnt(0)
    s_barrier
    ds_read_b32 v60, v12 offset:0
    ds_read_b32 v61, v12 offset:384
    ds_read_b32 v62, v12 offset:768
    ds_read_b32 v63, v12 offset:1152
    ds_read_b32 v64, v12 offset:1536
    ds_read_b32 v65, v12 offset:1920
    ds_read_b32 v66, v12 offset:2304
    ds_read2_b32 v[28:29], v13 offset0:1 offset1:2
    ds_read2_b32 v[30:31], v13 offset0:193 offset1:194
    ds_read2_b32 v[32:33], v16 offset0:1 offset1:2
    ds_read2_b32 v[34:35], v16 offset0:193 offset1:194
    v_add_u32 v3, 1024, v2
    v_add_u32 v4, 2048, v2
    v_mov_b32 v5, 0x1ffe0
    s_mov_b32 s37, s30
    s_add_u32 s38, s30, 1024
    s_add_u32 s39, s30, 2048
    s_mov_b32 s36, 0x1000
    s_mov_b32 s34, 0x1000
    s_waitcnt lgkmcnt(0)
    v_mov_b32 v8, v60
    v_lshrrev_b32 v7, 8, v8
    v_and_b32 v7, 0xfffe00, v7
    v_min_u32 v7, 12799488, v7
    v_and_or_b32 v11, v8, 28, s42
    v_lshlrev_b32 v11, v6, v11
    v_and_b32_dpp v9, v8, v5 quad_perm:[0,1,2,3] row_mask:0x3 bank_mask:0xf
    s_nop 0
    v_or_b32_dpp v11, v11, v11 quad_perm:[1,0,3,2] row_mask:0xf bank_mask:0xf
    v_and_b32_dpp v9, v8, v5 row_shr:4 row_mask:0xc bank_mask:0xf
    v_readlane_b32 s48, v11, 0
    v_readlane_b32 s49, v11, 16
    v_mfma_f32_4x4x4_16b_bf16 v[36:39], v[28:29], v[44:45], 0
    v_mfma_f32_4x4x4_16b_bf16 v[40:43], v[28:29], v[46:47], 0
    v_mfma_f32_4x4x4_16b_bf16 v[52:55], v[28:29], v[48:49], 0
    v_mfma_f32_4x4x4_16b_bf16 v[56:59], v[28:29], v[50:51], 0
    v_mov_b32 v28, 0
    v_mov_b32 v29, 0
    s_nop 0
    v_cvt_pk_bf16_f32 v68, v36, v40
    v_cvt_pk_bf16_f32 v70, v37, v41
    v_cvt_pk_bf16_f32 v72, v38, v42
    v_cvt_pk_bf16_f32 v74, v39, v43
    v_cvt_pk_bf16_f32 v69, v52, v56
    v_cvt_pk_bf16_f32 v71, v53, v57
    v_cvt_pk_bf16_f32 v73, v54, v58
    v_cvt_pk_bf16_f32 v75, v55, v59
    v_mfma_f32_4x4x4_16b_bf16 v[36:39], v[30:31], v[44:45], 0
    v_mfma_f32_4x4x4_16b_bf16 v[40:43], v[30:31], v[46:47], 0
    v_mfma_f32_4x4x4_16b_bf16 v[52:55], v[30:31], v[48:49], 0
    v_mfma_f32_4x4x4_16b_bf16 v[56:59], v[30:31], v[50:51], 0
    v_mov_b32 v30, 0
    v_mov_b32 v31, 0
    s_nop 0
    v_cvt_pk_bf16_f32 v76, v36, v40
    v_cvt_pk_bf16_f32 v78, v37, v41
    v_cvt_pk_bf16_f32 v80, v38, v42
    v_cvt_pk_bf16_f32 v82, v39, v43
    v_cvt_pk_bf16_f32 v77, v52, v56
    v_cvt_pk_bf16_f32 v79, v53, v57
    v_cvt_pk_bf16_f32 v81, v54, v58
    v_cvt_pk_bf16_f32 v83, v55, v59
    v_mfma_f32_4x4x4_16b_bf16 v[36:39], v[32:33], v[44:45], 0
    v_mfma_f32_4x4x4_16b_bf16 v[40:43], v[32:33], v[46:47], 0
    v_mfma_f32_4x4x4_16b_bf16 v[52:55], v[32:33], v[48:49], 0
    v_mfma_f32_4x4x4_16b_bf16 v[56:59], v[32:33], v[50:51], 0
    v_mov_b32 v32, 0
    v_mov_b32 v33, 0
    s_nop 0
    v_cvt_pk_bf16_f32 v84, v36, v40
    v_cvt_pk_bf16_f32 v86, v37, v41
    v_cvt_pk_bf16_f32 v88, v38, v42
    v_cvt_pk_bf16_f32 v90, v39, v43
    v_cvt_pk_bf16_f32 v85, v52, v56
    v_cvt_pk_bf16_f32 v87, v53, v57
    v_cvt_pk_bf16_f32 v89, v54, v58
    v_cvt_pk_bf16_f32 v91, v55, v59
    v_mfma_f32_4x4x4_16b_bf16 v[36:39], v[34:35], v[44:45], 0
    v_mfma_f32_4x4x4_16b_bf16 v[40:43], v[34:35], v[46:47], 0
    v_mfma_f32_4x4x4_16b_bf16 v[52:55], v[34:35], v[48:49], 0
    v_mfma_f32_4x4x4_16b_bf16 v[56:59], v[34:35], v[50:51], 0
    v_mov_b32 v34, 0
    v_mov_b32 v35, 0
    s_nop 0
    v_cvt_pk_bf16_f32 v92, v36, v40
    v_cvt_pk_bf16_f32 v94, v37, v41
    v_cvt_pk_bf16_f32 v93, v52, v56
    v_cvt_pk_bf16_f32 v95, v53, v57
    s_mov_b32 m0, s37
    v_add_u32_dpp v10, v7, v1 row_newbcast:0 row_mask:0xf bank_mask:0xf
    global_load_lds_dwordx4 v10, s[4:5]
    s_mov_b32 m0, s38
    v_add_u32_dpp v10, v7, v1 row_newbcast:1 row_mask:0xf bank_mask:0xf
    global_load_lds_dwordx4 v10, s[4:5]
    s_mov_b32 m0, s39
    v_add_u32_dpp v10, v7, v1 row_newbcast:2 row_mask:0xf bank_mask:0xf
    global_load_lds_dwordx4 v10, s[4:5]
    s_waitcnt vmcnt(3)
    v_add_u32_dpp v10, v7, v1 row_newbcast:3 row_mask:0xf bank_mask:0xf
    s_barrier
    s_setprio 1
    s_mov_b64 exec, s[56:57]
    ds_read_b128 v[28:31], v9 offset:50176
    ds_read_b128 v[32:35], v9 offset:50192
    s_mov_b64 exec, -1
    s_set_gpr_idx_on s37, 0
    s_mov_b32 m0, s34
    v_mov_b32 v12, v68
    v_mov_b32 v13, v69
    s_add_u32 s34, s34, 2
    s_mov_b32 m0, s37
    s_waitcnt vmcnt(2)
    ds_read_b64_tr_b16 v[14:15], v2
    ds_read_b64_tr_b16 v[16:17], v2 offset:256
.p2align 6
Lblk:
    s_sub_u32 s32, s32, 1
    s_waitcnt lgkmcnt(0)
    s_cbranch_scc1 Ltail0
    global_load_lds_dwordx4 v10, s[4:5]
Lback0:
    v_mfma_f32_32x32x16_bf16 v[44:59], v[28:31], v[20:23], 0
    v_mfma_f32_32x32x16_bf16 v[44:59], v[32:35], v[24:27], v[44:59]
    v_mfma_f32_4x4x4_16b_bf16 v[36:39], v[12:13], v[14:15], 0 cbsz:4 abid:0
    v_add_u32_dpp v10, v7, v1 row_newbcast:8 row_mask:0xf bank_mask:0xf
    v_mfma_f32_4x4x4_16b_bf16 v[40:43], v[12:13], v[16:17], 0 cbsz:4 abid:1
    v_readlane_b32 s50, v11, 2
    s_waitcnt vmcnt(2)
    ds_read_b64_tr_b16 v[14:15], v3
    ds_read_b64_tr_b16 v[16:17], v3 offset:256
    s_nop 3
    s_mov_b32 m0, s48
    v_pk_fma_f32 v[96:97], v[36:37], v[44:45], v[96:97] op_sel_hi:[1,0,1]
    v_pk_fma_f32 v[98:99], v[38:39], v[44:45], v[98:99] op_sel_hi:[1,0,1]
    s_mov_b32 m0, s49
    v_pk_fma_f32 v[96:97], v[40:41], v[52:53], v[96:97] op_sel_hi:[1,0,1]
    v_pk_fma_f32 v[98:99], v[42:43], v[52:53], v[98:99] op_sel_hi:[1,0,1]
    s_mov_b32 m0, s38
    s_sub_u32 s32, s32, 1
    s_waitcnt lgkmcnt(0)
    s_cbranch_scc1 Ltail1
    global_load_lds_dwordx4 v10, s[4:5]
Lback1:
    v_mfma_f32_4x4x4_16b_bf16 v[36:39], v[12:13], v[14:15], 0 cbsz:4 abid:2
    v_add_u32_dpp v10, v7, v1 row_newbcast:9 row_mask:0xf bank_mask:0xf
    v_mfma_f32_4x4x4_16b_bf16 v[40:43], v[12:13], v[16:17], 0 cbsz:4 abid:3
    v_readlane_b32 s51, v11, 18
    s_waitcnt vmcnt(2)
    ds_read_b64_tr_b16 v[14:15], v4
    ds_read_b64_tr_b16 v[16:17], v4 offset:256
    s_lshr_b32 m0, s48, 16
    v_pk_fma_f32 v[96:97], v[36:37], v[44:45], v[96:97] op_sel:[0,1,0] op_sel_hi:[1,1,1]
    v_pk_fma_f32 v[98:99], v[38:39], v[44:45], v[98:99] op_sel:[0,1,0] op_sel_hi:[1,1,1]
    s_lshr_b32 m0, s49, 16
    v_pk_fma_f32 v[96:97], v[40:41], v[52:53], v[96:97] op_sel:[0,1,0] op_sel_hi:[1,1,1]
    v_pk_fma_f32 v[98:99], v[42:43], v[52:53], v[98:99] op_sel:[0,1,0] op_sel_hi:[1,1,1]
    s_mov_b32 m0, s39
    s_sub_u32 s32, s32, 1
    s_waitcnt lgkmcnt(0)
    s_cbranch_scc1 Ltail2
    global_load_lds_dwordx4 v10, s[4:5]
Lback2:
    v_mfma_f32_4x4x4_16b_bf16 v[36:39], v[12:13], v[14:15], 0 cbsz:4 abid:4
    v_add_u32_dpp v10, v7, v1 row_newbcast:10 row_mask:0xf bank_mask:0xf
    v_mfma_f32_4x4x4_16b_bf16 v[40:43], v[12:13], v[16:17], 0 cbsz:4 abid:5
    v_readlane_b32 s48, v11, 8
    s_waitcnt vmcnt(2)
    ds_read_b64_tr_b16 v[14:15], v2
    ds_read_b64_tr_b16 v[16:17], v2 offset:256
    s_mov_b32 m0, s50
    v_pk_fma_f32 v[96:97], v[36:37], v[46:47], v[96:97] op_sel_hi:[1,0,1]
    v_pk_fma_f32 v[98:99], v[38:39], v[46:47], v[98:99] op_sel_hi:[1,0,1]
    s_mov_b32 m0, s51
    v_pk_fma_f32 v[96:97], v[40:41], v[54:55], v[96:97] op_sel_hi:[1,0,1]
    v_pk_fma_f32 v[98:99], v[42:43], v[54:55], v[98:99] op_sel_hi:[1,0,1]
    s_mov_b32 m0, s37
    s_sub_u32 s32, s32, 1
    s_waitcnt lgkmcnt(0)
    s_cbranch_scc1 Ltail3
    global_load_lds_dwordx4 v10, s[4:5]
Lback3:
    v_mfma_f32_4x4x4_16b_bf16 v[36:39], v[12:13], v[14:15], 0 cbsz:4 abid:6
    v_add_u32_dpp v10, v7, v1 row_newbcast:11 row_mask:0xf bank_mask:0xf
    v_mfma_f32_4x4x4_16b_bf16 v[40:43], v[12:13], v[16:17], 0 cbsz:4 abid:7
    v_readlane_b32 s49, v11, 24
    s_waitcnt vmcnt(2)
    ds_read_b64_tr_b16 v[14:15], v3
    ds_read_b64_tr_b16 v[16:17], v3 offset:256
    s_lshr_b32 m0, s50, 16
    v_pk_fma_f32 v[96:97], v[36:37], v[46:47], v[96:97] op_sel:[0,1,0] op_sel_hi:[1,1,1]
    v_pk_fma_f32 v[98:99], v[38:39], v[46:47], v[98:99] op_sel:[0,1,0] op_sel_hi:[1,1,1]
    s_lshr_b32 m0, s51, 16
    v_pk_fma_f32 v[96:97], v[40:41], v[54:55], v[96:97] op_sel:[0,1,0] op_sel_hi:[1,1,1]
    v_pk_fma_f32 v[98:99], v[42:43], v[54:55], v[98:99] op_sel:[0,1,0] op_sel_hi:[1,1,1]
    s_mov_b32 m0, s38
    s_sub_u32 s32, s32, 1
    s_waitcnt lgkmcnt(0)
    s_cbranch_scc1 Ltail4
    global_load_lds_dwordx4 v10, s[4:5]
Lback4:
    v_mfma_f32_4x4x4_16b_bf16 v[36:39], v[12:13], v[14:15], 0 cbsz:4 abid:8
    v_add_u32_dpp v10, v7, v1 row_newbcast:4 row_mask:0xf bank_mask:0xf
    v_mfma_f32_4x4x4_16b_bf16 v[40:43], v[12:13], v[16:17], 0 cbsz:4 abid:9
    v_readlane_b32 s50, v11, 10
    s_waitcnt vmcnt(2)
    ds_read_b64_tr_b16 v[14:15], v4
    ds_read_b64_tr_b16 v[16:17], v4 offset:256
    s_mov_b32 m0, s48
    v_pk_fma_f32 v[96:97], v[36:37], v[48:49], v[96:97] op_sel_hi:[1,0,1]
    v_pk_fma_f32 v[98:99], v[38:39], v[48:49], v[98:99] op_sel_hi:[1,0,1]
    s_mov_b32 m0, s49
    v_pk_fma_f32 v[96:97], v[40:41], v[56:57], v[96:97] op_sel_hi:[1,0,1]
    v_pk_fma_f32 v[98:99], v[42:43], v[56:57], v[98:99] op_sel_hi:[1,0,1]
    s_mov_b32 m0, s39
    s_sub_u32 s32, s32, 1
    s_waitcnt lgkmcnt(0)
    s_cbranch_scc1 Ltail5
    global_load_lds_dwordx4 v10, s[4:5]
Lback5:
    v_mfma_f32_4x4x4_16b_bf16 v[36:39], v[12:13], v[14:15], 0 cbsz:4 abid:10
    v_add_u32_dpp v10, v7, v1 row_newbcast:5 row_mask:0xf bank_mask:0xf
    v_mfma_f32_4x4x4_16b_bf16 v[40:43], v[12:13], v[16:17], 0 cbsz:4 abid:11
    v_readlane_b32 s51, v11, 26
    v_and_b32_dpp v9, v8, v5 row_shl:4 row_mask:0x3 bank_mask:0xf
    s_waitcnt vmcnt(2)
    ds_read_b64_tr_b16 v[14:15], v2
    ds_read_b64_tr_b16 v[16:17], v2 offset:256
    s_lshr_b32 m0, s48, 16
    v_pk_fma_f32 v[96:97], v[36:37], v[48:49], v[96:97] op_sel:[0,1,0] op_sel_hi:[1,1,1]
    v_pk_fma_f32 v[98:99], v[38:39], v[48:49], v[98:99] op_sel:[0,1,0] op_sel_hi:[1,1,1]
    s_lshr_b32 m0, s49, 16
    v_pk_fma_f32 v[96:97], v[40:41], v[56:57], v[96:97] op_sel:[0,1,0] op_sel_hi:[1,1,1]
    v_pk_fma_f32 v[98:99], v[42:43], v[56:57], v[98:99] op_sel:[0,1,0] op_sel_hi:[1,1,1]
    s_mov_b32 m0, s37
    s_sub_u32 s32, s32, 1
    s_waitcnt lgkmcnt(0)
    s_cbranch_scc1 Ltail6
    global_load_lds_dwordx4 v10, s[4:5]
Lback6:
    v_mfma_f32_4x4x4_16b_bf16 v[36:39], v[12:13], v[14:15], 0 cbsz:4 abid:12
    v_add_u32_dpp v10, v7, v1 row_newbcast:6 row_mask:0xf bank_mask:0xf
    v_mfma_f32_4x4x4_16b_bf16 v[40:43], v[12:13], v[16:17], 0 cbsz:4 abid:13
    v_readlane_b32 s48, v11, 4
    v_and_b32_dpp v9, v8, v5 quad_perm:[0,1,2,3] row_mask:0xc bank_mask:0xf
    s_waitcnt vmcnt(2)
    ds_read_b64_tr_b16 v[14:15], v3
    ds_read_b64_tr_b16 v[16:17], v3 offset:256
    s_mov_b32 m0, s50
    v_pk_fma_f32 v[96:97], v[36:37], v[50:51], v[96:97] op_sel_hi:[1,0,1]
    v_pk_fma_f32 v[98:99], v[38:39], v[50:51], v[98:99] op_sel_hi:[1,0,1]
    s_mov_b32 m0, s51
    v_pk_fma_f32 v[96:97], v[40:41], v[58:59], v[96:97] op_sel_hi:[1,0,1]
    v_pk_fma_f32 v[98:99], v[42:43], v[58:59], v[98:99] op_sel_hi:[1,0,1]
    s_mov_b32 m0, s38
    s_sub_u32 s32, s32, 1
    s_waitcnt lgkmcnt(0)
    s_cbranch_scc1 Ltail7
    global_load_lds_dwordx4 v10, s[4:5]
Lback7:
    v_mfma_f32_4x4x4_16b_bf16 v[36:39], v[12:13], v[14:15], 0 cbsz:4 abid:14
    v_add_u32_dpp v10, v7, v1 row_newbcast:7 row_mask:0xf bank_mask:0xf
    v_mfma_f32_4x4x4_16b_bf16 v[40:43], v[12:13], v[16:17], 0 cbsz:4 abid:15
    v_readlane_b32 s49, v11, 20
    s_mov_b32 m0, s34
    v_mov_b32 v12, v68
    v_mov_b32 v13, v69
    s_add_u32 s34, s34, 2
    s_waitcnt vmcnt(2)
    ds_read_b64_tr_b16 v[14:15], v4
    ds_read_b64_tr_b16 v[16:17], v4 offset:256
    s_mov_b64 exec, s[56:57]
    ds_read_b128 v[28:31], v9 offset:50176
    ds_read_b128 v[32:35], v9 offset:50192
    s_mov_b64 exec, -1
    s_lshr_b32 m0, s50, 16
    v_pk_fma_f32 v[96:97], v[36:37], v[50:51], v[96:97] op_sel:[0,1,0] op_sel_hi:[1,1,1]
    v_pk_fma_f32 v[98:99], v[38:39], v[50:51], v[98:99] op_sel:[0,1,0] op_sel_hi:[1,1,1]
    s_lshr_b32 m0, s51, 16
    v_pk_fma_f32 v[96:97], v[40:41], v[58:59], v[96:97] op_sel:[0,1,0] op_sel_hi:[1,1,1]
    v_pk_fma_f32 v[98:99], v[42:43], v[58:59], v[98:99] op_sel:[0,1,0] op_sel_hi:[1,1,1]
    s_mov_b32 m0, s39
    s_sub_u32 s32, s32, 1
    s_waitcnt lgkmcnt(0)
    s_cbranch_scc1 Ltail8
    global_load_lds_dwordx4 v10, s[4:5]
Lback8:
    v_mfma_f32_32x32x16_bf16 v[44:59], v[28:31], v[20:23], 0
    v_mfma_f32_32x32x16_bf16 v[44:59], v[32:35], v[24:27], v[44:59]
    v_mfma_f32_4x4x4_16b_bf16 v[36:39], v[12:13], v[14:15], 0 cbsz:4 abid:0
    v_add_u32_dpp v10, v7, v1 row_newbcast:12 row_mask:0xf bank_mask:0xf
    v_mfma_f32_4x4x4_16b_bf16 v[40:43], v[12:13], v[16:17], 0 cbsz:4 abid:1
    v_readlane_b32 s50, v11, 6
    s_waitcnt vmcnt(2)
    ds_read_b64_tr_b16 v[14:15], v2
    ds_read_b64_tr_b16 v[16:17], v2 offset:256
    s_nop 3
    s_mov_b32 m0, s48
    v_pk_fma_f32 v[96:97], v[36:37], v[44:45], v[96:97] op_sel_hi:[1,0,1]
    v_pk_fma_f32 v[98:99], v[38:39], v[44:45], v[98:99] op_sel_hi:[1,0,1]
    s_mov_b32 m0, s49
    v_pk_fma_f32 v[96:97], v[40:41], v[52:53], v[96:97] op_sel_hi:[1,0,1]
    v_pk_fma_f32 v[98:99], v[42:43], v[52:53], v[98:99] op_sel_hi:[1,0,1]
    s_mov_b32 m0, s37
    s_sub_u32 s32, s32, 1
    s_waitcnt lgkmcnt(0)
    s_cbranch_scc1 Ltail9
    global_load_lds_dwordx4 v10, s[4:5]
Lback9:
    v_mfma_f32_4x4x4_16b_bf16 v[36:39], v[12:13], v[14:15], 0 cbsz:4 abid:2
    v_add_u32_dpp v10, v7, v1 row_newbcast:13 row_mask:0xf bank_mask:0xf
    v_mfma_f32_4x4x4_16b_bf16 v[40:43], v[12:13], v[16:17], 0 cbsz:4 abid:3
    v_readlane_b32 s51, v11, 22
    s_waitcnt vmcnt(2)
    ds_read_b64_tr_b16 v[14:15], v3
    ds_read_b64_tr_b16 v[16:17], v3 offset:256
    s_lshr_b32 m0, s48, 16
    v_pk_fma_f32 v[96:97], v[36:37], v[44:45], v[96:97] op_sel:[0,1,0] op_sel_hi:[1,1,1]
    v_pk_fma_f32 v[98:99], v[38:39], v[44:45], v[98:99] op_sel:[0,1,0] op_sel_hi:[1,1,1]
    s_lshr_b32 m0, s49, 16
    v_pk_fma_f32 v[96:97], v[40:41], v[52:53], v[96:97] op_sel:[0,1,0] op_sel_hi:[1,1,1]
    v_pk_fma_f32 v[98:99], v[42:43], v[52:53], v[98:99] op_sel:[0,1,0] op_sel_hi:[1,1,1]
    s_mov_b32 m0, s38
    s_sub_u32 s32, s32, 1
    s_waitcnt lgkmcnt(0)
    s_cbranch_scc1 Ltail10
    global_load_lds_dwordx4 v10, s[4:5]
Lback10:
    v_mfma_f32_4x4x4_16b_bf16 v[36:39], v[12:13], v[14:15], 0 cbsz:4 abid:4
    v_add_u32_dpp v10, v7, v1 row_newbcast:14 row_mask:0xf bank_mask:0xf
    v_mfma_f32_4x4x4_16b_bf16 v[40:43], v[12:13], v[16:17], 0 cbsz:4 abid:5
    v_readlane_b32 s48, v11, 12
    s_waitcnt vmcnt(2)
    ds_read_b64_tr_b16 v[14:15], v4
    ds_read_b64_tr_b16 v[16:17], v4 offset:256
    s_mov_b32 m0, s50
    v_pk_fma_f32 v[96:97], v[36:37], v[46:47], v[96:97] op_sel_hi:[1,0,1]
    v_pk_fma_f32 v[98:99], v[38:39], v[46:47], v[98:99] op_sel_hi:[1,0,1]
    s_mov_b32 m0, s51
    v_pk_fma_f32 v[96:97], v[40:41], v[54:55], v[96:97] op_sel_hi:[1,0,1]
    v_pk_fma_f32 v[98:99], v[42:43], v[54:55], v[98:99] op_sel_hi:[1,0,1]
    s_mov_b32 m0, s39
    s_sub_u32 s32, s32, 1
    s_waitcnt lgkmcnt(0)
    s_cbranch_scc1 Ltail11
    global_load_lds_dwordx4 v10, s[4:5]
Lback11:
    v_mfma_f32_4x4x4_16b_bf16 v[36:39], v[12:13], v[14:15], 0 cbsz:4 abid:6
    v_add_u32_dpp v10, v7, v1 row_newbcast:15 row_mask:0xf bank_mask:0xf
    v_mfma_f32_4x4x4_16b_bf16 v[40:43], v[12:13], v[16:17], 0 cbsz:4 abid:7
    v_readlane_b32 s49, v11, 28
    s_waitcnt vmcnt(2)
    ds_read_b64_tr_b16 v[14:15], v2
    ds_read_b64_tr_b16 v[16:17], v2 offset:256
    s_lshr_b32 m0, s50, 16
    v_pk_fma_f32 v[96:97], v[36:37], v[46:47], v[96:97] op_sel:[0,1,0] op_sel_hi:[1,1,1]
    v_pk_fma_f32 v[98:99], v[38:39], v[46:47], v[98:99] op_sel:[0,1,0] op_sel_hi:[1,1,1]
    s_lshr_b32 m0, s51, 16
    v_pk_fma_f32 v[96:97], v[40:41], v[54:55], v[96:97] op_sel:[0,1,0] op_sel_hi:[1,1,1]
    v_pk_fma_f32 v[98:99], v[42:43], v[54:55], v[98:99] op_sel:[0,1,0] op_sel_hi:[1,1,1]
    s_add_u32 s36, s36, 1
    s_mov_b32 m0, s36
    v_mov_b32 v8, v60
    s_mov_b32 m0, s37
    s_sub_u32 s32, s32, 1
    s_waitcnt lgkmcnt(0)
    s_cbranch_scc1 Ltail12
    global_load_lds_dwordx4 v10, s[4:5]
Lback12:
    v_mfma_f32_4x4x4_16b_bf16 v[36:39], v[12:13], v[14:15], 0 cbsz:4 abid:8
    v_lshrrev_b32 v7, 8, v8
    v_mfma_f32_4x4x4_16b_bf16 v[40:43], v[12:13], v[16:17], 0 cbsz:4 abid:9
    v_and_b32 v7, 0xfffe00, v7
    v_min_u32 v7, 12799488, v7
    v_readlane_b32 s50, v11, 14
    s_nop 0
    v_add_u32_dpp v10, v7, v1 row_newbcast:0 row_mask:0xf bank_mask:0xf
    s_waitcnt vmcnt(2)
    ds_read_b64_tr_b16 v[14:15], v3
    ds_read_b64_tr_b16 v[16:17], v3 offset:256
    s_mov_b32 m0, s48
    v_pk_fma_f32 v[96:97], v[36:37], v[48:49], v[96:97] op_sel_hi:[1,0,1]
    v_pk_fma_f32 v[98:99], v[38:39], v[48:49], v[98:99] op_sel_hi:[1,0,1]
    s_mov_b32 m0, s49
    v_pk_fma_f32 v[96:97], v[40:41], v[56:57], v[96:97] op_sel_hi:[1,0,1]
    v_pk_fma_f32 v[98:99], v[42:43], v[56:57], v[98:99] op_sel_hi:[1,0,1]
    s_mov_b32 m0, s38
    s_sub_u32 s32, s32, 1
    s_waitcnt lgkmcnt(0)
    s_cbranch_scc1 Ltail13
    global_load_lds_dwordx4 v10, s[4:5]
Lback13:
    v_mfma_f32_4x4x4_16b_bf16 v[36:39], v[12:13], v[14:15], 0 cbsz:4 abid:10
    v_add_u32_dpp v10, v7, v1 row_newbcast:1 row_mask:0xf bank_mask:0xf
    v_mfma_f32_4x4x4_16b_bf16 v[40:43], v[12:13], v[16:17], 0 cbsz:4 abid:11
    v_readlane_b32 s51, v11, 30
    v_and_or_b32 v11, v8, 28, s42
    v_lshlrev_b32 v11, v6, v11
    v_and_b32_dpp v9, v8, v5 quad_perm:[0,1,2,3] row_mask:0x3 bank_mask:0xf
    s_waitcnt vmcnt(2)
    ds_read_b64_tr_b16 v[14:15], v4
    ds_read_b64_tr_b16 v[16:17], v4 offset:256
    s_lshr_b32 m0, s48, 16
    v_pk_fma_f32 v[96:97], v[36:37], v[48:49], v[96:97] op_sel:[0,1,0] op_sel_hi:[1,1,1]
    v_pk_fma_f32 v[98:99], v[38:39], v[48:49], v[98:99] op_sel:[0,1,0] op_sel_hi:[1,1,1]
    s_lshr_b32 m0, s49, 16
    v_pk_fma_f32 v[96:97], v[40:41], v[56:57], v[96:97] op_sel:[0,1,0] op_sel_hi:[1,1,1]
    v_pk_fma_f32 v[98:99], v[42:43], v[56:57], v[98:99] op_sel:[0,1,0] op_sel_hi:[1,1,1]
    s_mov_b32 m0, s39
    s_sub_u32 s32, s32, 1
    s_waitcnt lgkmcnt(0)
    s_cbranch_scc1 Ltail14
    global_load_lds_dwordx4 v10, s[4:5]
Lback14:
    v_mfma_f32_4x4x4_16b_bf16 v[36:39], v[12:13], v[14:15], 0 cbsz:4 abid:12
    v_add_u32_dpp v10, v7, v1 row_newbcast:2 row_mask:0xf bank_mask:0xf
    v_mfma_f32_4x4x4_16b_bf16 v[40:43], v[12:13], v[16:17], 0 cbsz:4 abid:13
    v_or_b32_dpp v11, v11, v11 quad_perm:[1,0,3,2] row_mask:0xf bank_mask:0xf
    v_and_b32_dpp v9, v8, v5 row_shr:4 row_mask:0xc bank_mask:0xf
    s_waitcnt vmcnt(2)
    ds_read_b64_tr_b16 v[14:15], v2
    ds_read_b64_tr_b16 v[16:17], v2 offset:256
    s_mov_b32 m0, s50
    v_pk_fma_f32 v[96:97], v[36:37], v[50:51], v[96:97] op_sel_hi:[1,0,1]
    v_pk_fma_f32 v[98:99], v[38:39], v[50:51], v[98:99] op_sel_hi:[1,0,1]
    s_mov_b32 m0, s51
    v_pk_fma_f32 v[96:97], v[40:41], v[58:59], v[96:97] op_sel_hi:[1,0,1]
    v_pk_fma_f32 v[98:99], v[42:43], v[58:59], v[98:99] op_sel_hi:[1,0,1]
    s_mov_b32 m0, s37
    s_sub_u32 s32, s32, 1
    s_waitcnt lgkmcnt(0)
    s_cbranch_scc1 Ltail15
    global_load_lds_dwordx4 v10, s[4:5]
Lback15:
    v_mfma_f32_4x4x4_16b_bf16 v[36:39], v[12:13], v[14:15], 0 cbsz:4 abid:14
    v_add_u32_dpp v10, v7, v1 row_newbcast:3 row_mask:0xf bank_mask:0xf
    v_mfma_f32_4x4x4_16b_bf16 v[40:43], v[12:13], v[16:17], 0 cbsz:4 abid:15
    v_readlane_b32 s48, v11, 0
    v_readlane_b32 s49, v11, 16
    s_mov_b32 m0, s34
    v_mov_b32 v12, v68
    v_mov_b32 v13, v69
    s_add_u32 s34, s34, 2
    s_waitcnt vmcnt(2)
    ds_read_b64_tr_b16 v[14:15], v3
    ds_read_b64_tr_b16 v[16:17], v3 offset:256
    s_mov_b64 exec, s[56:57]
    ds_read_b128 v[28:31], v9 offset:50176
    ds_read_b128 v[32:35], v9 offset:50192
    s_mov_b64 exec, -1
    s_lshr_b32 m0, s50, 16
    v_pk_fma_f32 v[96:97], v[36:37], v[50:51], v[96:97] op_sel:[0,1,0] op_sel_hi:[1,1,1]
    v_pk_fma_f32 v[98:99], v[38:39], v[50:51], v[98:99] op_sel:[0,1,0] op_sel_hi:[1,1,1]
    s_lshr_b32 m0, s51, 16
    v_pk_fma_f32 v[96:97], v[40:41], v[58:59], v[96:97] op_sel:[0,1,0] op_sel_hi:[1,1,1]
    v_pk_fma_f32 v[98:99], v[42:43], v[58:59], v[98:99] op_sel:[0,1,0] op_sel_hi:[1,1,1]
    s_mov_b32 m0, s38
    v_swap_b32 v2, v3
    v_swap_b32 v3, v4
    s_mov_b32 s58, s37
    s_mov_b32 s37, s38
    s_mov_b32 s38, s39
    s_mov_b32 s39, s58
    s_branch Lblk
Lloopend:
Ltail0:
    s_mov_b32 s32, 0
    s_sub_u32 s33, s33, 1
    s_cbranch_scc1 Lexit
    s_waitcnt vmcnt(0)
    s_branch Lback0
Ltail1:
    s_mov_b32 s32, 0
    s_sub_u32 s33, s33, 1
    s_cbranch_scc1 Lexit
    s_waitcnt vmcnt(0)
    s_branch Lback1
Ltail2:
    s_mov_b32 s32, 0
    s_sub_u32 s33, s33, 1
    s_cbranch_scc1 Lexit
    s_waitcnt vmcnt(0)
    s_branch Lback2
Ltail3:
    s_mov_b32 s32, 0
    s_sub_u32 s33, s33, 1
    s_cbranch_scc1 Lexit
    s_waitcnt vmcnt(0)
    s_branch Lback3
Ltail4:
    s_mov_b32 s32, 0
    s_sub_u32 s33, s33, 1
    s_cbranch_scc1 Lexit
    s_waitcnt vmcnt(0)
    s_branch Lback4
Ltail5:
    s_mov_b32 s32, 0
    s_sub_u32 s33, s33, 1
    s_cbranch_scc1 Lexit
    s_waitcnt vmcnt(0)
    s_branch Lback5
Ltail6:
    s_mov_b32 s32, 0
    s_sub_u32 s33, s33, 1
    s_cbranch_scc1 Lexit
    s_waitcnt vmcnt(0)
    s_branch Lback6
Ltail7:
    s_mov_b32 s32, 0
    s_sub_u32 s33, s33, 1
    s_cbranch_scc1 Lexit
    s_waitcnt vmcnt(0)
    s_branch Lback7
Ltail8:
    s_mov_b32 s32, 0
    s_sub_u32 s33, s33, 1
    s_cbranch_scc1 Lexit
    s_waitcnt vmcnt(0)
    s_branch Lback8
Ltail9:
    s_mov_b32 s32, 0
    s_sub_u32 s33, s33, 1
    s_cbranch_scc1 Lexit
    s_waitcnt vmcnt(0)
    s_branch Lback9
Ltail10:
    s_mov_b32 s32, 0
    s_sub_u32 s33, s33, 1
    s_cbranch_scc1 Lexit
    s_waitcnt vmcnt(0)
    s_branch Lback10
Ltail11:
    s_mov_b32 s32, 0
    s_sub_u32 s33, s33, 1
    s_cbranch_scc1 Lexit
    s_waitcnt vmcnt(0)
    s_branch Lback11
Ltail12:
    s_mov_b32 s32, 0
    s_sub_u32 s33, s33, 1
    s_cbranch_scc1 Lexit
    s_waitcnt vmcnt(0)
    s_branch Lback12
Ltail13:
    s_mov_b32 s32, 0
    s_sub_u32 s33, s33, 1
    s_cbranch_scc1 Lexit
    s_waitcnt vmcnt(0)
    s_branch Lback13
Ltail14:
    s_mov_b32 s32, 0
    s_sub_u32 s33, s33, 1
    s_cbranch_scc1 Lexit
    s_waitcnt vmcnt(0)
    s_branch Lback14
Ltail15:
    s_mov_b32 s32, 0
    s_sub_u32 s33, s33, 1
    s_cbranch_scc1 Lexit
    s_waitcnt vmcnt(0)
    s_branch Lback15
Lclip:
    s_add_u32 s58, s27, s29
    v_add_u32 v76, v64, v56
    v_min_u32 v76, s58, v76
    v_max_u32 v77, s27, v64
    v_sub_u32 v76, v76, v77
    v_max_i32 v56, 0, v76
    v_sub_u32 v76, v77, v64
    v_add_u32 v60, v60, v76
    v_subrev_u32 v64, s27, v77
    v_add_u32 v76, v65, v57
    v_min_u32 v76, s58, v76
    v_max_u32 v77, s27, v65
    v_sub_u32 v76, v76, v77
    v_max_i32 v57, 0, v76
    v_sub_u32 v76, v77, v65
    v_add_u32 v61, v61, v76
    v_subrev_u32 v65, s27, v77
    v_add_u32 v76, v66, v58
    v_min_u32 v76, s58, v76
    v_max_u32 v77, s27, v66
    v_sub_u32 v76, v76, v77
    v_max_i32 v58, 0, v76
    v_sub_u32 v76, v77, v66
    v_add_u32 v62, v62, v76
    v_subrev_u32 v66, s27, v77
    v_add_u32 v76, v67, v59
    v_min_u32 v76, s58, v76
    v_max_u32 v77, s27, v67
    v_sub_u32 v76, v76, v77
    v_max_i32 v59, 0, v76
    v_sub_u32 v76, v77, v67
    v_add_u32 v63, v63, v76
    v_subrev_u32 v67, s27, v77
    s_branch Lnoclip
Llatermap:
    s_barrier
    ds_write_b32 v82, v83 offset:2784
    s_add_u32 m0, s43, 0
    v_add_u32_dpp v10, v92, v6 quad_perm:[0,0,1,1] row_mask:0xf bank_mask:0xf
    global_load_lds_dwordx4 v10, s[10:11] sc1
    s_add_u32 m0, s43, 1024
    v_add_u32_dpp v10, v92, v6 quad_perm:[2,2,3,3] row_mask:0xf bank_mask:0xf
    global_load_lds_dwordx4 v10, s[10:11] sc1
    s_add_u32 m0, s43, 32768
    v_add_u32_dpp v10, v93, v6 quad_perm:[0,0,1,1] row_mask:0xf bank_mask:0xf
    global_load_lds_dwordx4 v10, s[10:11] sc1
    s_branch Lhavemap
Lover:
    ds_write_b32 v54, v83 offset:49656
    s_branch Loverb
Lslow:
    s_mov_b32 s28, 224
Lround:
    s_waitcnt vmcnt(0) lgkmcnt(0)
    s_barrier
    v_mov_b32 v80, 0
    ds_write_b32 v80, v80 offset:49656
    v_lshlrev_b32 v81, 4, v18
    s_waitcnt lgkmcnt(0)
    s_sub_u32 s58, s24, 10
    s_cmp_ge_u32 s58, 5
    s_cbranch_scc1 Lgo
    s_lshl_b32 s58, s25, 2
    v_lshl_add_u32 v82, v18, 12, s58
    buffer_load_dword v52, v82, s[16:19], 0 offen offset:0 sc1
    buffer_load_dword v53, v82, s[16:19], 0 offen offset:1024 sc1
    buffer_load_dword v54, v82, s[16:19], 0 offen offset:2048 sc1
    buffer_load_dword v55, v82, s[16:19], 0 offen offset:3072 sc1
    s_waitcnt vmcnt(0)
    s_branch Lhavetab
Lexit:
    s_set_gpr_idx_off
    s_setprio 0
    s_add_u32 s27, s27, s29
    s_cmp_lt_u32 s27, s26
    s_cbranch_scc1 Lround
    v_lshlrev_b32 v16, 4, v18
    s_cmp_ge_u32 s24, 4
    s_cbranch_scc1 Lnow
    s_waitcnt vmcnt(0)
    s_mov_b32 m0, s30
    s_lshl_b32 s58, s24, 11
    s_add_u32 s58, s58, 4096
    v_add_u32 v12, s58, v16
    global_load_lds_dwordx4 v12, s[12:13] sc1
    global_load_lds_dwordx4 v12, s[12:13] offset:1024 sc1
Lnow:
    v_lshrrev_b32 v13, 5, v18
    s_lshl_b32 s59, s24, 5
    v_lshl_add_u32 v14, v13, 4, s59
    ds_read_b128 v[84:87], v14 offset:49664
    v_cvt_pk_bf16_f32 v68, v96, v97
    v_cvt_pk_bf16_f32 v69, v98, v99
    v_cvt_pk_bf16_f32 v70, v100, v101
    v_cvt_pk_bf16_f32 v71, v102, v103
    v_cvt_pk_bf16_f32 v72, v104, v105
    v_cvt_pk_bf16_f32 v73, v106, v107
    v_cvt_pk_bf16_f32 v74, v108, v109
    v_cvt_pk_bf16_f32 v75, v110, v111
    v_cvt_pk_bf16_f32 v76, v112, v113
    v_cvt_pk_bf16_f32 v77, v114, v115
    v_cvt_pk_bf16_f32 v78, v116, v117
    v_cvt_pk_bf16_f32 v79, v118, v119
    v_cvt_pk_bf16_f32 v80, v120, v121
    v_cvt_pk_bf16_f32 v81, v122, v123
    s_mul_i32 s58, s24, 4608
    s_add_u32 s58, s58, 50176
    v_mul_u32_u24 v12, 72, v18
    v_add_u32 v12, s58, v12
    v_bfe_u32 v14, v18, 2, 2
    v_lshl_add_u32 v13, v13, 3, v14
    v_mul_u32_u24 v13, 72, v13
    v_bfe_u32 v14, v18, 4, 1
    v_lshl_add_u32 v13, v14, 5, v13
    v_and_b32 v14, 3, v18
    v_lshl_add_u32 v13, v14, 3, v13
    v_add_u32 v13, s58, v13
    s_mul_i32 s59, s25, 50176
    v_and_b32 v15, 31, v18
    v_lshl_add_u32 v15, v15, 2, s59
    s_waitcnt vmcnt(0) lgkmcnt(0)
    v_add_u32 v84, v84, v15
    v_add_u32 v85, v85, v15
    v_add_u32 v86, v86, v15
    v_add_u32 v87, v87, v15
    s_barrier
    s_cmp_lt_u32 s24, 14
    s_cbranch_scc1 Lsix
    ds_write_b64 v12, v[80:81] offset:48
Lsix:
    ds_write_b64 v12, v[68:69] offset:0
    ds_write_b64 v12, v[70:71] offset:8
    ds_write_b64 v12, v[72:73] offset:16
    ds_write_b64 v12, v[74:75] offset:24
    ds_write_b64 v12, v[76:77] offset:32
    ds_write_b64 v12, v[78:79] offset:40
    ds_read_b64_tr_b16 v[20:21], v13 offset:0
    ds_read_b64_tr_b16 v[22:23], v13 offset:288
    ds_read_b128 v[36:39], v16 offset:0
    ds_read_b128 v[40:43], v16 offset:1024
    ds_read_b64_tr_b16 v[24:25], v13 offset:1152
    ds_read_b64_tr_b16 v[26:27], v13 offset:1440
    ds_read_b128 v[44:47], v16 offset:3072
    ds_read_b128 v[48:51], v16 offset:4096
    s_waitcnt lgkmcnt(7)
    ds_read_b64_tr_b16 v[28:29], v13 offset:2304
    ds_read_b64_tr_b16 v[30:31], v13 offset:2592
    ds_read_b128 v[52:55], v16 offset:6144
    ds_read_b128 v[56:59], v16 offset:7168
    ds_read_b64_tr_b16 v[32:33], v13 offset:3456
    ds_read_b64_tr_b16 v[34:35], v13 offset:3744
    ds_read_b128 v[60:63], v16 offset:9216
    ds_read_b128 v[64:67], v16 offset:10240
    s_waitcnt lgkmcnt(12)
    v_mfma_f32_32x32x16_bf16 v[96:111], v[20:23], v[36:39], 0
    v_mfma_f32_32x32x16_bf16 v[112:127], v[20:23], v[40:43], 0
    s_waitcnt lgkmcnt(8)
    v_mfma_f32_32x32x16_bf16 v[96:111], v[24:27], v[44:47], v[96:111]
    v_mfma_f32_32x32x16_bf16 v[112:127], v[24:27], v[48:51], v[112:127]
    s_waitcnt lgkmcnt(4)
    v_mfma_f32_32x32x16_bf16 v[96:111], v[28:31], v[52:55], v[96:111]
    v_mfma_f32_32x32x16_bf16 v[112:127], v[28:31], v[56:59], v[112:127]
    s_waitcnt lgkmcnt(0)
    v_mfma_f32_32x32x16_bf16 v[96:111], v[32:35], v[60:63], v[96:111]
    v_mfma_f32_32x32x16_bf16 v[112:127], v[32:35], v[64:67], v[112:127]
    s_nop 11
    v_cvt_pk_bf16_f32 v36, v96, v112
    buffer_store_dword v36, v84, s[20:23], 0 offen offset:0 sc1
    v_cvt_pk_bf16_f32 v37, v97, v113
    buffer_store_dword v37, v84, s[20:23], 0 offen offset:128 sc1
    v_cvt_pk_bf16_f32 v38, v98, v114
    buffer_store_dword v38, v84, s[20:23], 0 offen offset:256 sc1
    v_cvt_pk_bf16_f32 v39, v99, v115
    buffer_store_dword v39, v84, s[20:23], 0 offen offset:384 sc1
    v_cvt_pk_bf16_f32 v40, v100, v116
    buffer_store_dword v40, v85, s[20:23], 0 offen offset:0 sc1
    v_cvt_pk_bf16_f32 v41, v101, v117
    buffer_store_dword v41, v85, s[20:23], 0 offen offset:128 sc1
    v_cvt_pk_bf16_f32 v42, v102, v118
    buffer_store_dword v42, v85, s[20:23], 0 offen offset:256 sc1
    v_cvt_pk_bf16_f32 v43, v103, v119
    buffer_store_dword v43, v85, s[20:23], 0 offen offset:384 sc1
    v_cvt_pk_bf16_f32 v44, v104, v120
    buffer_store_dword v44, v86, s[20:23], 0 offen offset:0 sc1
    v_cvt_pk_bf16_f32 v45, v105, v121
    buffer_store_dword v45, v86, s[20:23], 0 offen offset:128 sc1
    v_cvt_pk_bf16_f32 v46, v106, v122
    buffer_store_dword v46, v86, s[20:23], 0 offen offset:256 sc1
    v_cvt_pk_bf16_f32 v47, v107, v123
    buffer_store_dword v47, v86, s[20:23], 0 offen offset:384 sc1
    s_cmp_lt_u32 s24, 14
    s_cbranch_scc1 Lfin
    v_cvt_pk_bf16_f32 v48, v108, v124
    buffer_store_dword v48, v87, s[20:23], 0 offen offset:0 sc1
    v_cvt_pk_bf16_f32 v49, v109, v125
    buffer_store_dword v49, v87, s[20:23], 0 offen offset:128 sc1
    v_cvt_pk_bf16_f32 v50, v110, v126
    buffer_store_dword v50, v87, s[20:23], 0 offen offset:256 sc1
    v_cvt_pk_bf16_f32 v51, v111, v127
    buffer_store_dword v51, v87, s[20:23], 0 offen offset:384 sc1
Lfin:
Lend:
    s_endpgm
.section .rodata,"a"
.p2align 6
.amdhsa_kernel standalone__tensor_product_equiv_mace__graph_kernel
  .amdhsa_next_free_vgpr 128
  .amdhsa_next_free_sgpr 96
  .amdhsa_accum_offset 128
  .amdhsa_group_segment_fixed_size 0
  .amdhsa_kernarg_size 88
  .amdhsa_user_sgpr_count 2
  .amdhsa_user_sgpr_kernarg_segment_ptr 1
  .amdhsa_system_sgpr_workgroup_id_x 1
  .amdhsa_float_denorm_mode_32 3
.end_amdhsa_kernel
```
